```python
import torch

def _softmax(x, axis=-1):
    return torch.softmax(x, dim=axis)
def _gelu(x):
    return torch.nn.functional.gelu(x, approximate="tanh")
def _silu(x):
    return torch.nn.functional.silu(x)
def _sigmoid(x):
    return torch.sigmoid(x)
def _layernorm(x, axis=-1, eps=1e-5):
    m = x.mean(dim=axis, keepdim=True)
    v = x.var(dim=axis, keepdim=True, unbiased=False)
    return (x - m) / torch.sqrt(v + eps)
def _scatter_add(tgt, idx, src, axis=0):
    return tgt.clone().index_add_(axis, idx, src)
def _segment_sum(src, seg, n):
    out = torch.zeros((n,) + src.shape[1:], dtype=src.dtype)
    return out.index_add_(0, seg, src)
def _pad(x, pw):
    flat = tuple(v for pair in reversed(pw) for v in pair)
    return torch.nn.functional.pad(x, flat)

kernel_name = 'concat_heads__mha_block_cached__gqa_block_cached__near_ridge'

def setup_inputs():

    _w = (lambda a: (lambda t: t.to(torch.bfloat16) if t.is_floating_point() else t)(torch.as_tensor(a)))
    def _A_setup():
        B, Sq, D = 8, 192, 640
        H, Sk, Dh = 32, 512, 128
        return {
            "x": _w((lambda *s: torch.randn(*s, dtype=torch.bfloat16) * 0.8)(B, Sq, D)),
            "k_cache": _w((lambda *s: torch.randn(*s, dtype=torch.bfloat16) * 0.8)(B, H, Sk, Dh)),
            "v_cache": _w((lambda *s: torch.randn(*s, dtype=torch.bfloat16) * 0.05)(B, H, Sk, Dh)),
            "wq": _w((lambda *s: torch.randn(*s, dtype=torch.bfloat16) * 0.8)(D, H * Dh) * (D ** -0.5)),
            "wo": _w((lambda *s: torch.randn(*s, dtype=torch.bfloat16) * 0.05)(H * Dh, D) * ((H * Dh) ** -0.5)),
        }
    _A_in = _A_setup()

    def _B_setup():
        B, Sq, D = 8, 192, 640
        Hq, Hkv, Sk, Dh = 32, 32, 512, 128
        assert Hq % Hkv == 0, (Hq, Hkv)
        return {
            "x": _w((lambda *s: torch.randn(*s, dtype=torch.bfloat16) * 0.8)(B, Sq, D)),
            "k_cache": _w((lambda *s: torch.randn(*s, dtype=torch.bfloat16) * 0.8)(B, Hkv, Sk, Dh)),
            "v_cache": _w((lambda *s: torch.randn(*s, dtype=torch.bfloat16) * 0.05)(B, Hkv, Sk, Dh)),
            "wq": _w((lambda *s: torch.randn(*s, dtype=torch.bfloat16) * 0.8)(D, Hq * Dh) * (D ** -0.5)),
            "wo": _w((lambda *s: torch.randn(*s, dtype=torch.bfloat16) * 0.05)(Hq * Dh, D) * ((Hq * Dh) ** -0.5)),
        }
    _B_in = _B_setup()

    return {
        "A_x": _A_in["x"],
        "A_k_cache": _A_in["k_cache"],
        "A_v_cache": _A_in["v_cache"],
        "A_wq": _A_in["wq"],
        "A_wo": _A_in["wo"],
        "B_x": _B_in["x"],
        "B_k_cache": _B_in["k_cache"],
        "B_v_cache": _B_in["v_cache"],
        "B_wq": _B_in["wq"],
        "B_wo": _B_in["wo"],
    }

def reference(A_x, A_k_cache, A_v_cache, A_wq, A_wo, B_x, B_k_cache, B_v_cache, B_wq, B_wo):
    def _A_ref(x, k_cache, v_cache, wq, wo):
        B, Sq, D = x.shape
        H, Dh = 32, 128
        q = (lambda x, *d: x.permute(*d))((x @ wq).reshape(B, Sq, H, Dh), 0, 2, 1, 3)
        scores = torch.einsum("bhqd,bhkd->bhqk", q, k_cache) * (Dh ** -0.5)
        p = _softmax(scores, axis=-1)
        o = torch.einsum("bhqk,bhkd->bhqd", p, v_cache)
        return (lambda x, *d: x.permute(*d))(o, 0, 2, 1, 3).reshape(B, Sq, H * Dh) @ wo

    def _B_ref(x, k_cache, v_cache, wq, wo):
        B, Sq, D = x.shape
        Hq, Dh = 32, 128
        Hkv = k_cache.shape[1]
        rep = Hq // Hkv
        q = (lambda x, *d: x.permute(*d))((x @ wq).reshape(B, Sq, Hq, Dh), 0, 2, 1, 3)
        k = (lambda x, n, axis: torch.repeat_interleave(x, n, dim=axis))(k_cache, rep, axis=1)
        v = (lambda x, n, axis: torch.repeat_interleave(x, n, dim=axis))(v_cache, rep, axis=1)
        scores = torch.einsum("bhqd,bhkd->bhqk", q, k) * (Dh ** -0.5)
        p = _softmax(scores, axis=-1)
        o = torch.einsum("bhqk,bhkd->bhqd", p, v)
        return (lambda x, *d: x.permute(*d))(o, 0, 2, 1, 3).reshape(B, Sq, Hq * Dh) @ wo

    a = _A_ref(A_x, A_k_cache, A_v_cache, A_wq, A_wo)
    b = _B_ref(B_x, B_k_cache, B_v_cache, B_wq, B_wo)
    return torch.concatenate([a, b], axis=-1)
```

```asm
; @launch grid=(752,1,1) block=(256,1,1) lds=81920
.amdgcn_target "amdgcn-amd-amdhsa--gfx950"
.text
.globl concat_heads__mha_block_cached__gqa_block_cached__near_ridge_kernel
.p2align 8
.type concat_heads__mha_block_cached__gqa_block_cached__near_ridge_kernel,@function
concat_heads__mha_block_cached__gqa_block_cached__near_ridge_kernel:
  s_cmp_ge_u32 s2, 752
  s_cbranch_scc1 concat_heads__mha_block_cached__gqa_block_cached__near_ridge_kernel_end
  s_cmp_ge_u32 s2, 512
  s_cbranch_scc1 concat_heads__mha_block_cached__gqa_block_cached__near_ridge_kernel_oproj
  s_lshr_b32 s79, s2, 8
  s_and_b32 s72, s2, 255
  s_bfe_u32 s5, s72, 0x10002
  s_mul_i32 s3, s5, 40
  s_load_dwordx4 s[52:55], s[0:1], s3
  s_add_u32 s44, s3, 16
  s_load_dwordx4 s[56:59], s[0:1], s44
  s_load_dwordx2 s[60:61], s[0:1], 96
  s_load_dwordx2 s[74:75], s[0:1], 88
  s_add_u32 s44, s3, 32
  s_load_dwordx2 s[62:63], s[0:1], s44
  s_load_dwordx2 s[76:77], s[0:1], 32
  s_bfe_u32 s6, s72, 0x10001
  s_lshl_b32 s6, s6, 2
  s_lshr_b32 s44, s72, 6
  s_add_u32 s6, s6, s44
  s_and_b32 s7, s72, 1
  s_lshl_b32 s7, s7, 3
  s_bfe_u32 s44, s72, 0x30003
  s_add_u32 s7, s7, s44
  s_lshl_b32 s44, s79, 4
  s_add_u32 s7, s7, s44
  v_lshrrev_b32 v248, 6, v0
  v_and_b32 v0, 63, v0
  s_nop 0
  v_readfirstlane_b32 s4, v248
  v_lshrrev_b32 v248, 4, v0
  v_and_b32 v249, 15, v0
  v_bfe_u32 v250, v0, 2, 2
  v_and_b32 v251, 3, v0
  v_lshlrev_b32 v3, 4, v0
  s_lshr_b32 s43, s4, 1
  s_and_b32 s43, s43, 1
  s_lshl_b32 s43, s43, 2
  v_or_b32 v16, s43, v248
  v_lshrrev_b32 v17, 1, v249
  v_xor_b32 v16, v16, v17
  v_lshlrev_b32 v16, 5, v16
  v_and_b32 v17, 1, v249
  v_lshl_add_u32 v16, v17, 4, v16
  v_lshl_add_u32 v1, v248, 13, v16
  s_and_b32 s43, s4, 1
  s_lshl_b32 s43, s43, 2
  v_add_u32 v16, s43, v248
  v_and_b32 v17, 7, v0
  v_xor_b32 v17, v17, v16
  v_lshlrev_b32 v17, 4, v17
  v_lshrrev_b32 v16, 3, v0
  v_mul_u32_u24 v16, 1280, v16
  v_add_u32 v2, v16, v17
  s_lshl_b32 s8, s4, 15
  s_mul_i32 s9, s4, 10240
  s_lshl_b32 s36, s4, 10
  s_add_u32 s37, s36, 16384
  s_and_b32 s43, s7, 7
  s_lshr_b32 s44, s43, 2
  s_add_u32 s43, s43, s44
  s_and_b32 s44, s6, 3
  s_mul_i32 s44, s44, 5
  s_add_u32 s44, s44, 1
  s_lshr_b32 s44, s44, 1
  s_add_u32 s10, s43, s44
  s_cmp_ge_u32 s10, 10
  s_cselect_b32 s43, 10, 0
  s_sub_u32 s10, s10, s43
  s_waitcnt lgkmcnt(0)
  s_mov_b32 s64, s74
  s_and_b32 s65, s75, 0xffff
  s_mov_b32 s66, 256
  s_mov_b32 s67, 0x20000
  s_or_b32 s43, s2, s4
  s_cmp_eq_u32 s43, 0
  s_cbranch_scc0 concat_heads__mha_block_cached__gqa_block_cached__near_ridge_kernel_h_nononce
  s_memrealtime s[46:47]
  s_waitcnt lgkmcnt(0)
  s_or_b32 s43, s46, 1
  v_mov_b32 v255, s43
  v_mov_b32 v254, 0
  buffer_store_dword v255, v254, s[64:67], 0 offen sc1
concat_heads__mha_block_cached__gqa_block_cached__near_ridge_kernel_h_nononce:
  s_lshl_b32 s43, s7, 8
  s_add_u32 s12, s58, s43
  s_addc_u32 s13, s59, 0
  s_and_b32 s13, s13, 0xffff
  s_mov_b32 s14, 5234944
  s_mov_b32 s15, 0x20000
  s_mul_i32 s43, s6, 245760
  s_add_u32 s16, s52, s43
  s_addc_u32 s17, s53, 0
  s_and_b32 s17, s17, 0xffff
  s_mov_b32 s18, 245760
  s_mov_b32 s19, 0x20000
  s_lshl_b32 s43, s10, 19
  s_add_u32 s32, s8, s43
  s_lshl_b32 s43, s10, 7
  s_add_u32 s33, s9, s43
  s_add_u32 s10, s10, 1
  s_cmp_eq_u32 s10, 10
  s_cselect_b32 s10, 0, s10
  s_mov_b32 m0, s36
  s_nop 0
  buffer_load_dwordx4 v1, s[12:15], s32 offen lds
  s_add_u32 m0, s36, 4096
  s_nop 0
  s_add_u32 s11, s32, 131072
  buffer_load_dwordx4 v1, s[12:15], s11 offen lds
  s_add_u32 m0, s36, 8192
  s_nop 0
  s_add_u32 s11, s32, 262144
  buffer_load_dwordx4 v1, s[12:15], s11 offen lds
  s_add_u32 m0, s36, 12288
  s_nop 0
  s_add_u32 s11, s32, 393216
  buffer_load_dwordx4 v1, s[12:15], s11 offen lds
  s_mov_b32 m0, s37
  s_nop 0
  buffer_load_dwordx4 v2, s[16:19], s33 offen lds
  s_add_u32 m0, s37, 4096
  s_nop 0
  s_add_u32 s11, s33, 40960
  buffer_load_dwordx4 v2, s[16:19], s11 offen lds
  s_add_u32 m0, s37, 8192
  s_nop 0
  s_add_u32 s11, s33, 81920
  buffer_load_dwordx4 v2, s[16:19], s11 offen lds
  s_add_u32 m0, s37, 12288
  s_nop 0
  s_add_u32 s11, s33, 122880
  buffer_load_dwordx4 v2, s[16:19], s11 offen lds
  s_add_u32 m0, s37, 16384
  s_nop 0
  s_add_u32 s11, s33, 163840
  buffer_load_dwordx4 v2, s[16:19], s11 offen lds
  s_add_u32 m0, s37, 20480
  s_nop 0
  s_add_u32 s11, s33, 204800
  buffer_load_dwordx4 v2, s[16:19], s11 offen lds
  s_cmp_eq_u32 s79, 0
  s_cbranch_scc0 concat_heads__mha_block_cached__gqa_block_cached__near_ridge_kernel_h_prb
  s_setprio 1
  s_branch concat_heads__mha_block_cached__gqa_block_cached__near_ridge_kernel_h_noprio
concat_heads__mha_block_cached__gqa_block_cached__near_ridge_kernel_h_prb:
  s_setprio 0
concat_heads__mha_block_cached__gqa_block_cached__near_ridge_kernel_h_noprio:
  s_lshl_b32 s44, s6, 5
  s_add_u32 s44, s44, s7
  s_lshl_b32 s43, s44, 17
  s_add_u32 s20, s54, s43
  s_addc_u32 s21, s55, 0
  s_and_b32 s21, s21, 0xffff
  s_mov_b32 s22, 131072
  s_mov_b32 s23, 0x20000
  s_add_u32 s24, s56, s43
  s_addc_u32 s25, s57, 0
  s_and_b32 s25, s25, 0xffff
  s_mov_b32 s26, 131072
  s_mov_b32 s27, 0x20000
  s_mul_i32 s44, s5, 12582912
  s_lshl_b32 s45, s7, 15
  s_add_u32 s43, s44, s45
  s_add_u32 s28, s60, s43
  s_addc_u32 s29, s61, 0
  s_and_b32 s29, s29, 0xffff
  s_mov_b32 s30, 11567104
  s_mov_b32 s31, 0x20000
  s_lshr_b32 s43, s72, 3
  s_lshl_b32 s43, s43, 2
  s_and_b32 s44, s72, 3
  s_add_u32 s43, s43, s44
  s_lshl_b32 s44, s79, 7
  s_add_u32 s43, s43, s44
  s_mul_i32 s43, s43, 20480
  s_add_u32 s68, s62, s43
  s_addc_u32 s69, s63, 0
  s_and_b32 s69, s69, 0xffff
  s_mov_b32 s70, 20480
  s_mov_b32 s71, 0x20000
  s_mov_b32 s50, 0x3e0293ee
  s_mov_b32 s51, 0x3e0293ee
  v_and_b32 v16, 1, v248
  v_lshl_or_b32 v16, v16, 2, v250
  v_lshl_add_u32 v17, v248, 3, v250
  v_lshlrev_b32 v17, 8, v17
  v_lshl_add_u32 v17, v251, 3, v17
  v_xor_b32 v4, 0, v16
  v_lshl_add_u32 v4, v4, 5, v17
  v_xor_b32 v5, 1, v16
  v_lshl_add_u32 v5, v5, 5, v17
  v_xor_b32 v6, 2, v16
  v_lshl_add_u32 v6, v6, 5, v17
  v_xor_b32 v7, 3, v16
  v_lshl_add_u32 v7, v7, 5, v17
  v_xor_b32 v8, 4, v16
  v_lshl_add_u32 v8, v8, 5, v17
  v_xor_b32 v9, 5, v16
  v_lshl_add_u32 v9, v9, 5, v17
  v_xor_b32 v10, 6, v16
  v_lshl_add_u32 v10, v10, 5, v17
  v_xor_b32 v11, 7, v16
  v_lshl_add_u32 v11, v11, 5, v17
  v_lshrrev_b32 v16, 1, v249
  v_xor_b32 v16, v248, v16
  v_lshlrev_b32 v16, 4, v16
  v_lshl_add_u32 v16, v249, 7, v16
  s_mul_i32 s3, s4, 6144
  s_add_u32 s3, s3, 16384
  v_add_u32 v12, s3, v16
  v_xor_b32 v15, 64, v12
  v_and_b32 v16, 7, v249
  v_lshrrev_b32 v17, 1, v16
  v_lshlrev_b32 v17, 2, v17
  v_and_b32 v13, 1, v16
  v_add_u32 v17, v17, v13
  v_lshlrev_b32 v17, 4, v17
  v_lshl_add_u32 v17, v16, 10, v17
  v_lshrrev_b32 v16, 3, v249
  v_lshl_add_u32 v17, v16, 8, v17
  v_and_b32 v16, 1, v248
  v_lshlrev_b32 v16, 1, v16
  v_lshrrev_b32 v13, 1, v248
  v_or_b32 v16, v16, v13
  v_lshl_add_u32 v13, v16, 4, v17
  v_and_b32 v16, 1, v248
  v_lshl_add_u32 v16, v16, 2, v250
  v_mul_u32_u24 v16, 1056, v16
  v_lshrrev_b32 v17, 1, v248
  v_lshl_add_u32 v16, v17, 8, v16
  v_lshl_add_u32 v16, v251, 3, v16
  v_add_u32 v14, 8448, v16
  v_mov_b32 v16, 0
  v_mov_b32 v17, 0
  v_mov_b32 v18, 0
  v_mov_b32 v19, 0
  v_mov_b32 v20, 0
  v_mov_b32 v21, 0
  v_mov_b32 v22, 0
  v_mov_b32 v23, 0
  v_mov_b32 v24, 0
  v_mov_b32 v25, 0
  v_mov_b32 v26, 0
  v_mov_b32 v27, 0
  v_mov_b32 v28, 0
  v_mov_b32 v29, 0
  v_mov_b32 v30, 0
  v_mov_b32 v31, 0
  v_mov_b32 v32, 0
  v_mov_b32 v33, 0
  v_mov_b32 v34, 0
  v_mov_b32 v35, 0
  v_mov_b32 v36, 0
  v_mov_b32 v37, 0
  v_mov_b32 v38, 0
  v_mov_b32 v39, 0
  v_mov_b32 v40, 0
  v_mov_b32 v41, 0
  v_mov_b32 v42, 0
  v_mov_b32 v43, 0
  v_mov_b32 v44, 0
  v_mov_b32 v45, 0
  v_mov_b32 v46, 0
  v_mov_b32 v47, 0
  v_mov_b32 v48, 0
  v_mov_b32 v49, 0
  v_mov_b32 v50, 0
  v_mov_b32 v51, 0
  v_mov_b32 v52, 0
  v_mov_b32 v53, 0
  v_mov_b32 v54, 0
  v_mov_b32 v55, 0
  v_mov_b32 v56, 0
  v_mov_b32 v57, 0
  v_mov_b32 v58, 0
  v_mov_b32 v59, 0
  v_mov_b32 v60, 0
  v_mov_b32 v61, 0
  v_mov_b32 v62, 0
  v_mov_b32 v63, 0
  v_mov_b32 v64, 0
  v_mov_b32 v65, 0
  v_mov_b32 v66, 0
  v_mov_b32 v67, 0
  v_mov_b32 v68, 0
  v_mov_b32 v69, 0
  v_mov_b32 v70, 0
  v_mov_b32 v71, 0
  v_mov_b32 v72, 0
  v_mov_b32 v73, 0
  v_mov_b32 v74, 0
  v_mov_b32 v75, 0
  v_mov_b32 v76, 0
  v_mov_b32 v77, 0
  v_mov_b32 v78, 0
  v_mov_b32 v79, 0
  v_mov_b32 v80, 0
  v_mov_b32 v81, 0
  v_mov_b32 v82, 0
  v_mov_b32 v83, 0
  v_mov_b32 v84, 0
  v_mov_b32 v85, 0
  v_mov_b32 v86, 0
  v_mov_b32 v87, 0
  v_mov_b32 v88, 0
  v_mov_b32 v89, 0
  v_mov_b32 v90, 0
  v_mov_b32 v91, 0
  v_mov_b32 v92, 0
  v_mov_b32 v93, 0
  v_mov_b32 v94, 0
  v_mov_b32 v95, 0
  v_mov_b32 v96, 0
  v_mov_b32 v97, 0
  v_mov_b32 v98, 0
  v_mov_b32 v99, 0
  v_mov_b32 v100, 0
  v_mov_b32 v101, 0
  v_mov_b32 v102, 0
  v_mov_b32 v103, 0
  v_mov_b32 v104, 0
  v_mov_b32 v105, 0
  v_mov_b32 v106, 0
  v_mov_b32 v107, 0
  v_mov_b32 v108, 0
  v_mov_b32 v109, 0
  v_mov_b32 v110, 0
  v_mov_b32 v111, 0
  s_lshl_b32 s43, s10, 19
  s_add_u32 s32, s8, s43
  s_lshl_b32 s43, s10, 7
  s_add_u32 s33, s9, s43
  s_add_u32 s10, s10, 1
  s_cmp_eq_u32 s10, 10
  s_cselect_b32 s10, 0, s10
  s_add_u32 m0, s36, 40960
  s_nop 0
  buffer_load_dwordx4 v1, s[12:15], s32 offen lds
  s_add_u32 m0, s36, 45056
  s_nop 0
  s_add_u32 s11, s32, 131072
  buffer_load_dwordx4 v1, s[12:15], s11 offen lds
  s_add_u32 m0, s36, 49152
  s_nop 0
  s_add_u32 s11, s32, 262144
  buffer_load_dwordx4 v1, s[12:15], s11 offen lds
  s_add_u32 m0, s36, 53248
  s_nop 0
  s_add_u32 s11, s32, 393216
  buffer_load_dwordx4 v1, s[12:15], s11 offen lds
  s_add_u32 m0, s37, 40960
  s_nop 0
  buffer_load_dwordx4 v2, s[16:19], s33 offen lds
  s_add_u32 m0, s37, 45056
  s_nop 0
  s_add_u32 s11, s33, 40960
  buffer_load_dwordx4 v2, s[16:19], s11 offen lds
  s_add_u32 m0, s37, 49152
  s_nop 0
  s_add_u32 s11, s33, 81920
  buffer_load_dwordx4 v2, s[16:19], s11 offen lds
  s_add_u32 m0, s37, 53248
  s_nop 0
  s_add_u32 s11, s33, 122880
  buffer_load_dwordx4 v2, s[16:19], s11 offen lds
  s_add_u32 m0, s37, 57344
  s_nop 0
  s_add_u32 s11, s33, 163840
  buffer_load_dwordx4 v2, s[16:19], s11 offen lds
  s_add_u32 m0, s37, 61440
  s_nop 0
  s_add_u32 s11, s33, 204800
  buffer_load_dwordx4 v2, s[16:19], s11 offen lds
  s_waitcnt vmcnt(10)
  s_barrier
  ds_read_b128 v[192:195], v12 offset:0
  ds_read_b128 v[196:199], v12 offset:2048
  ds_read_b128 v[200:203], v12 offset:4096
  ds_read_b64_tr_b16 v[160:161], v4 offset:0
  ds_read_b64_tr_b16 v[162:163], v4 offset:1024
  ds_read_b64_tr_b16 v[164:165], v5 offset:0
  ds_read_b64_tr_b16 v[166:167], v5 offset:1024
  ds_read_b64_tr_b16 v[168:169], v6 offset:0
  ds_read_b64_tr_b16 v[170:171], v6 offset:1024
  ds_read_b64_tr_b16 v[172:173], v7 offset:0
  ds_read_b64_tr_b16 v[174:175], v7 offset:1024
  ds_read_b64_tr_b16 v[176:177], v8 offset:0
  ds_read_b64_tr_b16 v[178:179], v8 offset:1024
  ds_read_b64_tr_b16 v[180:181], v9 offset:0
  ds_read_b64_tr_b16 v[182:183], v9 offset:1024
  ds_read_b64_tr_b16 v[184:185], v10 offset:0
  ds_read_b64_tr_b16 v[186:187], v10 offset:1024
  ds_read_b64_tr_b16 v[188:189], v11 offset:0
  ds_read_b64_tr_b16 v[190:191], v11 offset:1024
  s_mov_b32 s42, 4
concat_heads__mha_block_cached__gqa_block_cached__near_ridge_kernel_h_qloop:
  s_waitcnt lgkmcnt(14)
  v_mfma_f32_16x16x32_bf16 v[16:19], v[160:163], v[192:195], v[16:19]
  ds_read_b128 v[236:239], v15 offset:0
  v_mfma_f32_16x16x32_bf16 v[20:23], v[160:163], v[196:199], v[20:23]
  ds_read_b128 v[240:243], v15 offset:2048
  v_mfma_f32_16x16x32_bf16 v[24:27], v[160:163], v[200:203], v[24:27]
  ds_read_b128 v[244:247], v15 offset:4096
  s_waitcnt lgkmcnt(15)
  v_mfma_f32_16x16x32_bf16 v[28:31], v[164:167], v[192:195], v[28:31]
  ds_read_b64_tr_b16 v[204:205], v4 offset:8192
  v_mfma_f32_16x16x32_bf16 v[32:35], v[164:167], v[196:199], v[32:35]
  ds_read_b64_tr_b16 v[206:207], v4 offset:9216
  v_mfma_f32_16x16x32_bf16 v[36:39], v[164:167], v[200:203], v[36:39]
  ds_read_b64_tr_b16 v[208:209], v5 offset:8192
  s_waitcnt lgkmcnt(15)
  v_mfma_f32_16x16x32_bf16 v[40:43], v[168:171], v[192:195], v[40:43]
  ds_read_b64_tr_b16 v[210:211], v5 offset:9216
  v_mfma_f32_16x16x32_bf16 v[44:47], v[168:171], v[196:199], v[44:47]
  ds_read_b64_tr_b16 v[212:213], v6 offset:8192
  v_mfma_f32_16x16x32_bf16 v[48:51], v[168:171], v[200:203], v[48:51]
  ds_read_b64_tr_b16 v[214:215], v6 offset:9216
  s_waitcnt lgkmcnt(15)
  v_mfma_f32_16x16x32_bf16 v[52:55], v[172:175], v[192:195], v[52:55]
  ds_read_b64_tr_b16 v[216:217], v7 offset:8192
  v_mfma_f32_16x16x32_bf16 v[56:59], v[172:175], v[196:199], v[56:59]
  ds_read_b64_tr_b16 v[218:219], v7 offset:9216
  v_mfma_f32_16x16x32_bf16 v[60:63], v[172:175], v[200:203], v[60:63]
  ds_read_b64_tr_b16 v[220:221], v8 offset:8192
  v_mfma_f32_16x16x32_bf16 v[64:67], v[176:179], v[192:195], v[64:67]
  ds_read_b64_tr_b16 v[222:223], v8 offset:9216
  v_mfma_f32_16x16x32_bf16 v[68:71], v[176:179], v[196:199], v[68:71]
  ds_read_b64_tr_b16 v[224:225], v9 offset:8192
  v_mfma_f32_16x16x32_bf16 v[72:75], v[176:179], v[200:203], v[72:75]
  ds_read_b64_tr_b16 v[226:227], v9 offset:9216
  s_waitcnt lgkmcnt(15)
  v_mfma_f32_16x16x32_bf16 v[76:79], v[180:183], v[192:195], v[76:79]
  ds_read_b64_tr_b16 v[228:229], v10 offset:8192
  v_mfma_f32_16x16x32_bf16 v[80:83], v[180:183], v[196:199], v[80:83]
  ds_read_b64_tr_b16 v[230:231], v10 offset:9216
  v_mfma_f32_16x16x32_bf16 v[84:87], v[180:183], v[200:203], v[84:87]
  ds_read_b64_tr_b16 v[232:233], v11 offset:8192
  v_mfma_f32_16x16x32_bf16 v[88:91], v[184:187], v[192:195], v[88:91]
  ds_read_b64_tr_b16 v[234:235], v11 offset:9216
  v_mfma_f32_16x16x32_bf16 v[92:95], v[184:187], v[196:199], v[92:95]
  v_mfma_f32_16x16x32_bf16 v[96:99], v[184:187], v[200:203], v[96:99]
  v_mfma_f32_16x16x32_bf16 v[100:103], v[188:191], v[192:195], v[100:103]
  v_mfma_f32_16x16x32_bf16 v[104:107], v[188:191], v[196:199], v[104:107]
  v_mfma_f32_16x16x32_bf16 v[108:111], v[188:191], v[200:203], v[108:111]
  s_waitcnt vmcnt(0) lgkmcnt(0)
  s_barrier
  v_mfma_f32_16x16x32_bf16 v[16:19], v[204:207], v[236:239], v[16:19]
  ds_read_b128 v[192:195], v12 offset:40960
  s_lshl_b32 s43, s10, 19
  v_mfma_f32_16x16x32_bf16 v[20:23], v[204:207], v[240:243], v[20:23]
  ds_read_b128 v[196:199], v12 offset:43008
  s_add_u32 s32, s8, s43
  s_lshl_b32 s43, s10, 7
  s_add_u32 s33, s9, s43
  s_add_u32 s10, s10, 1
  s_cmp_eq_u32 s10, 10
  s_cselect_b32 s10, 0, s10
  v_mfma_f32_16x16x32_bf16 v[24:27], v[204:207], v[244:247], v[24:27]
  ds_read_b128 v[200:203], v12 offset:45056
  s_mov_b32 m0, s36
  v_mfma_f32_16x16x32_bf16 v[28:31], v[208:211], v[236:239], v[28:31]
  ds_read_b64_tr_b16 v[160:161], v4 offset:40960
  buffer_load_dwordx4 v1, s[12:15], s32 offen lds
  v_mfma_f32_16x16x32_bf16 v[32:35], v[208:211], v[240:243], v[32:35]
  ds_read_b64_tr_b16 v[162:163], v4 offset:41984
  s_add_u32 m0, s36, 4096
  v_mfma_f32_16x16x32_bf16 v[36:39], v[208:211], v[244:247], v[36:39]
  ds_read_b64_tr_b16 v[164:165], v5 offset:40960
  s_add_u32 s11, s32, 131072
  buffer_load_dwordx4 v1, s[12:15], s11 offen lds
  v_mfma_f32_16x16x32_bf16 v[40:43], v[212:215], v[236:239], v[40:43]
  ds_read_b64_tr_b16 v[166:167], v5 offset:41984
  s_add_u32 m0, s36, 8192
  v_mfma_f32_16x16x32_bf16 v[44:47], v[212:215], v[240:243], v[44:47]
  ds_read_b64_tr_b16 v[168:169], v6 offset:40960
  s_add_u32 s11, s32, 262144
  buffer_load_dwordx4 v1, s[12:15], s11 offen lds
  v_mfma_f32_16x16x32_bf16 v[48:51], v[212:215], v[244:247], v[48:51]
  ds_read_b64_tr_b16 v[170:171], v6 offset:41984
  s_add_u32 m0, s36, 12288
  v_mfma_f32_16x16x32_bf16 v[52:55], v[216:219], v[236:239], v[52:55]
  ds_read_b64_tr_b16 v[172:173], v7 offset:40960
  s_add_u32 s11, s32, 393216
  buffer_load_dwordx4 v1, s[12:15], s11 offen lds
  v_mfma_f32_16x16x32_bf16 v[56:59], v[216:219], v[240:243], v[56:59]
  ds_read_b64_tr_b16 v[174:175], v7 offset:41984
  s_mov_b32 m0, s37
  v_mfma_f32_16x16x32_bf16 v[60:63], v[216:219], v[244:247], v[60:63]
  ds_read_b64_tr_b16 v[176:177], v8 offset:40960
  buffer_load_dwordx4 v2, s[16:19], s33 offen lds
  v_mfma_f32_16x16x32_bf16 v[64:67], v[220:223], v[236:239], v[64:67]
  ds_read_b64_tr_b16 v[178:179], v8 offset:41984
  s_add_u32 m0, s37, 4096
  v_mfma_f32_16x16x32_bf16 v[68:71], v[220:223], v[240:243], v[68:71]
  ds_read_b64_tr_b16 v[180:181], v9 offset:40960
  s_add_u32 s11, s33, 40960
  buffer_load_dwordx4 v2, s[16:19], s11 offen lds
  v_mfma_f32_16x16x32_bf16 v[72:75], v[220:223], v[244:247], v[72:75]
  ds_read_b64_tr_b16 v[182:183], v9 offset:41984
  s_add_u32 m0, s37, 8192
  v_mfma_f32_16x16x32_bf16 v[76:79], v[224:227], v[236:239], v[76:79]
  ds_read_b64_tr_b16 v[184:185], v10 offset:40960
  s_add_u32 s11, s33, 81920
  buffer_load_dwordx4 v2, s[16:19], s11 offen lds
  v_mfma_f32_16x16x32_bf16 v[80:83], v[224:227], v[240:243], v[80:83]
  ds_read_b64_tr_b16 v[186:187], v10 offset:41984
  s_add_u32 m0, s37, 12288
  v_mfma_f32_16x16x32_bf16 v[84:87], v[224:227], v[244:247], v[84:87]
  ds_read_b64_tr_b16 v[188:189], v11 offset:40960
  s_add_u32 s11, s33, 122880
  buffer_load_dwordx4 v2, s[16:19], s11 offen lds
  v_mfma_f32_16x16x32_bf16 v[88:91], v[228:231], v[236:239], v[88:91]
  ds_read_b64_tr_b16 v[190:191], v11 offset:41984
  s_add_u32 m0, s37, 16384
  v_mfma_f32_16x16x32_bf16 v[92:95], v[228:231], v[240:243], v[92:95]
  s_add_u32 s11, s33, 163840
  buffer_load_dwordx4 v2, s[16:19], s11 offen lds
  v_mfma_f32_16x16x32_bf16 v[96:99], v[228:231], v[244:247], v[96:99]
  s_add_u32 m0, s37, 20480
  v_mfma_f32_16x16x32_bf16 v[100:103], v[232:235], v[236:239], v[100:103]
  s_add_u32 s11, s33, 204800
  buffer_load_dwordx4 v2, s[16:19], s11 offen lds
  v_mfma_f32_16x16x32_bf16 v[104:107], v[232:235], v[240:243], v[104:107]
  v_mfma_f32_16x16x32_bf16 v[108:111], v[232:235], v[244:247], v[108:111]
  s_waitcnt lgkmcnt(14)
  v_mfma_f32_16x16x32_bf16 v[16:19], v[160:163], v[192:195], v[16:19]
  ds_read_b128 v[236:239], v15 offset:40960
  v_mfma_f32_16x16x32_bf16 v[20:23], v[160:163], v[196:199], v[20:23]
  ds_read_b128 v[240:243], v15 offset:43008
  v_mfma_f32_16x16x32_bf16 v[24:27], v[160:163], v[200:203], v[24:27]
  ds_read_b128 v[244:247], v15 offset:45056
  s_waitcnt lgkmcnt(15)
  v_mfma_f32_16x16x32_bf16 v[28:31], v[164:167], v[192:195], v[28:31]
  ds_read_b64_tr_b16 v[204:205], v4 offset:49152
  v_mfma_f32_16x16x32_bf16 v[32:35], v[164:167], v[196:199], v[32:35]
  ds_read_b64_tr_b16 v[206:207], v4 offset:50176
  v_mfma_f32_16x16x32_bf16 v[36:39], v[164:167], v[200:203], v[36:39]
  ds_read_b64_tr_b16 v[208:209], v5 offset:49152
  s_waitcnt lgkmcnt(15)
  v_mfma_f32_16x16x32_bf16 v[40:43], v[168:171], v[192:195], v[40:43]
  ds_read_b64_tr_b16 v[210:211], v5 offset:50176
  v_mfma_f32_16x16x32_bf16 v[44:47], v[168:171], v[196:199], v[44:47]
  ds_read_b64_tr_b16 v[212:213], v6 offset:49152
  v_mfma_f32_16x16x32_bf16 v[48:51], v[168:171], v[200:203], v[48:51]
  ds_read_b64_tr_b16 v[214:215], v6 offset:50176
  s_waitcnt lgkmcnt(15)
  v_mfma_f32_16x16x32_bf16 v[52:55], v[172:175], v[192:195], v[52:55]
  ds_read_b64_tr_b16 v[216:217], v7 offset:49152
  v_mfma_f32_16x16x32_bf16 v[56:59], v[172:175], v[196:199], v[56:59]
  ds_read_b64_tr_b16 v[218:219], v7 offset:50176
  v_mfma_f32_16x16x32_bf16 v[60:63], v[172:175], v[200:203], v[60:63]
  ds_read_b64_tr_b16 v[220:221], v8 offset:49152
  v_mfma_f32_16x16x32_bf16 v[64:67], v[176:179], v[192:195], v[64:67]
  ds_read_b64_tr_b16 v[222:223], v8 offset:50176
  v_mfma_f32_16x16x32_bf16 v[68:71], v[176:179], v[196:199], v[68:71]
  ds_read_b64_tr_b16 v[224:225], v9 offset:49152
  v_mfma_f32_16x16x32_bf16 v[72:75], v[176:179], v[200:203], v[72:75]
  ds_read_b64_tr_b16 v[226:227], v9 offset:50176
  s_waitcnt lgkmcnt(15)
  v_mfma_f32_16x16x32_bf16 v[76:79], v[180:183], v[192:195], v[76:79]
  ds_read_b64_tr_b16 v[228:229], v10 offset:49152
  v_mfma_f32_16x16x32_bf16 v[80:83], v[180:183], v[196:199], v[80:83]
  ds_read_b64_tr_b16 v[230:231], v10 offset:50176
  v_mfma_f32_16x16x32_bf16 v[84:87], v[180:183], v[200:203], v[84:87]
  ds_read_b64_tr_b16 v[232:233], v11 offset:49152
  v_mfma_f32_16x16x32_bf16 v[88:91], v[184:187], v[192:195], v[88:91]
  ds_read_b64_tr_b16 v[234:235], v11 offset:50176
  v_mfma_f32_16x16x32_bf16 v[92:95], v[184:187], v[196:199], v[92:95]
  v_mfma_f32_16x16x32_bf16 v[96:99], v[184:187], v[200:203], v[96:99]
  v_mfma_f32_16x16x32_bf16 v[100:103], v[188:191], v[192:195], v[100:103]
  v_mfma_f32_16x16x32_bf16 v[104:107], v[188:191], v[196:199], v[104:107]
  v_mfma_f32_16x16x32_bf16 v[108:111], v[188:191], v[200:203], v[108:111]
  s_waitcnt vmcnt(0) lgkmcnt(0)
  s_barrier
  v_mfma_f32_16x16x32_bf16 v[16:19], v[204:207], v[236:239], v[16:19]
  ds_read_b128 v[192:195], v12 offset:0
  s_lshl_b32 s43, s10, 19
  v_mfma_f32_16x16x32_bf16 v[20:23], v[204:207], v[240:243], v[20:23]
  ds_read_b128 v[196:199], v12 offset:2048
  s_add_u32 s32, s8, s43
  s_lshl_b32 s43, s10, 7
  s_add_u32 s33, s9, s43
  s_add_u32 s10, s10, 1
  s_cmp_eq_u32 s10, 10
  s_cselect_b32 s10, 0, s10
  v_mfma_f32_16x16x32_bf16 v[24:27], v[204:207], v[244:247], v[24:27]
  ds_read_b128 v[200:203], v12 offset:4096
  s_add_u32 m0, s36, 40960
  v_mfma_f32_16x16x32_bf16 v[28:31], v[208:211], v[236:239], v[28:31]
  ds_read_b64_tr_b16 v[160:161], v4 offset:0
  buffer_load_dwordx4 v1, s[12:15], s32 offen lds
  v_mfma_f32_16x16x32_bf16 v[32:35], v[208:211], v[240:243], v[32:35]
  ds_read_b64_tr_b16 v[162:163], v4 offset:1024
  s_add_u32 m0, s36, 45056
  v_mfma_f32_16x16x32_bf16 v[36:39], v[208:211], v[244:247], v[36:39]
  ds_read_b64_tr_b16 v[164:165], v5 offset:0
  s_add_u32 s11, s32, 131072
  buffer_load_dwordx4 v1, s[12:15], s11 offen lds
  v_mfma_f32_16x16x32_bf16 v[40:43], v[212:215], v[236:239], v[40:43]
  ds_read_b64_tr_b16 v[166:167], v5 offset:1024
  s_add_u32 m0, s36, 49152
  v_mfma_f32_16x16x32_bf16 v[44:47], v[212:215], v[240:243], v[44:47]
  ds_read_b64_tr_b16 v[168:169], v6 offset:0
  s_add_u32 s11, s32, 262144
  buffer_load_dwordx4 v1, s[12:15], s11 offen lds
  v_mfma_f32_16x16x32_bf16 v[48:51], v[212:215], v[244:247], v[48:51]
  ds_read_b64_tr_b16 v[170:171], v6 offset:1024
  s_add_u32 m0, s36, 53248
  v_mfma_f32_16x16x32_bf16 v[52:55], v[216:219], v[236:239], v[52:55]
  ds_read_b64_tr_b16 v[172:173], v7 offset:0
  s_add_u32 s11, s32, 393216
  buffer_load_dwordx4 v1, s[12:15], s11 offen lds
  v_mfma_f32_16x16x32_bf16 v[56:59], v[216:219], v[240:243], v[56:59]
  ds_read_b64_tr_b16 v[174:175], v7 offset:1024
  s_add_u32 m0, s37, 40960
  v_mfma_f32_16x16x32_bf16 v[60:63], v[216:219], v[244:247], v[60:63]
  ds_read_b64_tr_b16 v[176:177], v8 offset:0
  buffer_load_dwordx4 v2, s[16:19], s33 offen lds
  v_mfma_f32_16x16x32_bf16 v[64:67], v[220:223], v[236:239], v[64:67]
  ds_read_b64_tr_b16 v[178:179], v8 offset:1024
  s_add_u32 m0, s37, 45056
  v_mfma_f32_16x16x32_bf16 v[68:71], v[220:223], v[240:243], v[68:71]
  ds_read_b64_tr_b16 v[180:181], v9 offset:0
  s_add_u32 s11, s33, 40960
  buffer_load_dwordx4 v2, s[16:19], s11 offen lds
  v_mfma_f32_16x16x32_bf16 v[72:75], v[220:223], v[244:247], v[72:75]
  ds_read_b64_tr_b16 v[182:183], v9 offset:1024
  s_add_u32 m0, s37, 49152
  v_mfma_f32_16x16x32_bf16 v[76:79], v[224:227], v[236:239], v[76:79]
  ds_read_b64_tr_b16 v[184:185], v10 offset:0
  s_add_u32 s11, s33, 81920
  buffer_load_dwordx4 v2, s[16:19], s11 offen lds
  v_mfma_f32_16x16x32_bf16 v[80:83], v[224:227], v[240:243], v[80:83]
  ds_read_b64_tr_b16 v[186:187], v10 offset:1024
  s_add_u32 m0, s37, 53248
  v_mfma_f32_16x16x32_bf16 v[84:87], v[224:227], v[244:247], v[84:87]
  ds_read_b64_tr_b16 v[188:189], v11 offset:0
  s_add_u32 s11, s33, 122880
  buffer_load_dwordx4 v2, s[16:19], s11 offen lds
  v_mfma_f32_16x16x32_bf16 v[88:91], v[228:231], v[236:239], v[88:91]
  ds_read_b64_tr_b16 v[190:191], v11 offset:1024
  s_add_u32 m0, s37, 57344
  v_mfma_f32_16x16x32_bf16 v[92:95], v[228:231], v[240:243], v[92:95]
  s_add_u32 s11, s33, 163840
  buffer_load_dwordx4 v2, s[16:19], s11 offen lds
  v_mfma_f32_16x16x32_bf16 v[96:99], v[228:231], v[244:247], v[96:99]
  s_add_u32 m0, s37, 61440
  v_mfma_f32_16x16x32_bf16 v[100:103], v[232:235], v[236:239], v[100:103]
  s_add_u32 s11, s33, 204800
  buffer_load_dwordx4 v2, s[16:19], s11 offen lds
  v_mfma_f32_16x16x32_bf16 v[104:107], v[232:235], v[240:243], v[104:107]
  v_mfma_f32_16x16x32_bf16 v[108:111], v[232:235], v[244:247], v[108:111]
  s_sub_u32 s42, s42, 1
  s_cmp_lg_u32 s42, 0
  s_cbranch_scc1 concat_heads__mha_block_cached__gqa_block_cached__near_ridge_kernel_h_qloop
  s_nop 0
  s_mul_i32 s43, s4, 5120
  buffer_load_dword v255, v3, s[68:71], s43 offen
  buffer_load_dword v255, v3, s[68:71], s43 offen offset:1024
  buffer_load_dword v255, v3, s[68:71], s43 offen offset:2048
  buffer_load_dword v255, v3, s[68:71], s43 offen offset:3072
  s_add_u32 s43, s43, 4096
  buffer_load_dword v255, v3, s[68:71], s43 offen
  s_lshr_b32 s43, s4, 1
  s_lshl_b32 s43, s43, 2
  s_and_b32 s44, s4, 1
  s_add_u32 s43, s43, s44
  s_lshl_b32 s43, s43, 4
  s_lshl_b32 s44, s4, 10
  s_add_u32 s38, s43, s44
  s_add_u32 s39, s38, 4224
  s_mul_i32 s43, s4, 1056
  s_add_u32 s40, s43, 8448
  s_add_u32 s41, s40, 4224
  s_lshl_b32 s36, s4, 10
  s_mov_b32 s8, 0
  s_mov_b32 s9, 0
  s_mov_b32 s32, s36
  s_add_u32 s33, s36, 4096
  s_mov_b32 s34, s32
  s_mov_b32 s35, s33
  s_waitcnt lgkmcnt(14)
  v_mfma_f32_16x16x32_bf16 v[16:19], v[160:163], v[192:195], v[16:19]
  ds_read_b128 v[236:239], v15 offset:0
  v_mfma_f32_16x16x32_bf16 v[20:23], v[160:163], v[196:199], v[20:23]
  ds_read_b128 v[240:243], v15 offset:2048
  v_mfma_f32_16x16x32_bf16 v[24:27], v[160:163], v[200:203], v[24:27]
  ds_read_b128 v[244:247], v15 offset:4096
  s_waitcnt lgkmcnt(15)
  v_mfma_f32_16x16x32_bf16 v[28:31], v[164:167], v[192:195], v[28:31]
  ds_read_b64_tr_b16 v[204:205], v4 offset:8192
  v_mfma_f32_16x16x32_bf16 v[32:35], v[164:167], v[196:199], v[32:35]
  ds_read_b64_tr_b16 v[206:207], v4 offset:9216
  v_mfma_f32_16x16x32_bf16 v[36:39], v[164:167], v[200:203], v[36:39]
  ds_read_b64_tr_b16 v[208:209], v5 offset:8192
  s_waitcnt lgkmcnt(15)
  v_mfma_f32_16x16x32_bf16 v[40:43], v[168:171], v[192:195], v[40:43]
  ds_read_b64_tr_b16 v[210:211], v5 offset:9216
  v_mfma_f32_16x16x32_bf16 v[44:47], v[168:171], v[196:199], v[44:47]
  ds_read_b64_tr_b16 v[212:213], v6 offset:8192
  v_mfma_f32_16x16x32_bf16 v[48:51], v[168:171], v[200:203], v[48:51]
  ds_read_b64_tr_b16 v[214:215], v6 offset:9216
  s_waitcnt lgkmcnt(15)
  v_mfma_f32_16x16x32_bf16 v[52:55], v[172:175], v[192:195], v[52:55]
  ds_read_b64_tr_b16 v[216:217], v7 offset:8192
  v_mfma_f32_16x16x32_bf16 v[56:59], v[172:175], v[196:199], v[56:59]
  ds_read_b64_tr_b16 v[218:219], v7 offset:9216
  v_mfma_f32_16x16x32_bf16 v[60:63], v[172:175], v[200:203], v[60:63]
  ds_read_b64_tr_b16 v[220:221], v8 offset:8192
  v_mfma_f32_16x16x32_bf16 v[64:67], v[176:179], v[192:195], v[64:67]
  ds_read_b64_tr_b16 v[222:223], v8 offset:9216
  v_mfma_f32_16x16x32_bf16 v[68:71], v[176:179], v[196:199], v[68:71]
  ds_read_b64_tr_b16 v[224:225], v9 offset:8192
  v_mfma_f32_16x16x32_bf16 v[72:75], v[176:179], v[200:203], v[72:75]
  ds_read_b64_tr_b16 v[226:227], v9 offset:9216
  s_waitcnt lgkmcnt(15)
  v_mfma_f32_16x16x32_bf16 v[76:79], v[180:183], v[192:195], v[76:79]
  ds_read_b64_tr_b16 v[228:229], v10 offset:8192
  v_mfma_f32_16x16x32_bf16 v[80:83], v[180:183], v[196:199], v[80:83]
  ds_read_b64_tr_b16 v[230:231], v10 offset:9216
  v_mfma_f32_16x16x32_bf16 v[84:87], v[180:183], v[200:203], v[84:87]
  ds_read_b64_tr_b16 v[232:233], v11 offset:8192
  v_mfma_f32_16x16x32_bf16 v[88:91], v[184:187], v[192:195], v[88:91]
  ds_read_b64_tr_b16 v[234:235], v11 offset:9216
  v_mfma_f32_16x16x32_bf16 v[92:95], v[184:187], v[196:199], v[92:95]
  v_mfma_f32_16x16x32_bf16 v[96:99], v[184:187], v[200:203], v[96:99]
  v_mfma_f32_16x16x32_bf16 v[100:103], v[188:191], v[192:195], v[100:103]
  v_mfma_f32_16x16x32_bf16 v[104:107], v[188:191], v[196:199], v[104:107]
  v_mfma_f32_16x16x32_bf16 v[108:111], v[188:191], v[200:203], v[108:111]
  s_waitcnt vmcnt(0) lgkmcnt(0)
  s_barrier
  v_mfma_f32_16x16x32_bf16 v[16:19], v[204:207], v[236:239], v[16:19]
  ds_read_b128 v[192:195], v12 offset:40960
  s_mov_b32 m0, s38
  v_mfma_f32_16x16x32_bf16 v[20:23], v[204:207], v[240:243], v[20:23]
  ds_read_b128 v[196:199], v12 offset:43008
  buffer_load_dwordx4 v3, s[20:23], s32 offen nt lds
  s_add_u32 s32, s32, 8192
  v_mfma_f32_16x16x32_bf16 v[24:27], v[204:207], v[244:247], v[24:27]
  ds_read_b128 v[200:203], v12 offset:45056
  s_mov_b32 m0, s39
  v_mfma_f32_16x16x32_bf16 v[28:31], v[208:211], v[236:239], v[28:31]
  ds_read_b64_tr_b16 v[160:161], v4 offset:40960
  buffer_load_dwordx4 v3, s[20:23], s33 offen nt lds
  s_add_u32 s33, s33, 8192
  v_mfma_f32_16x16x32_bf16 v[32:35], v[208:211], v[240:243], v[32:35]
  ds_read_b64_tr_b16 v[162:163], v4 offset:41984
  v_mfma_f32_16x16x32_bf16 v[36:39], v[208:211], v[244:247], v[36:39]
  ds_read_b64_tr_b16 v[164:165], v5 offset:40960
  s_mov_b32 m0, s40
  v_mfma_f32_16x16x32_bf16 v[40:43], v[212:215], v[236:239], v[40:43]
  ds_read_b64_tr_b16 v[166:167], v5 offset:41984
  buffer_load_dwordx4 v3, s[24:27], s34 offen nt lds
  s_add_u32 s34, s34, 8192
  v_mfma_f32_16x16x32_bf16 v[44:47], v[212:215], v[240:243], v[44:47]
  ds_read_b64_tr_b16 v[168:169], v6 offset:40960
  v_mfma_f32_16x16x32_bf16 v[48:51], v[212:215], v[244:247], v[48:51]
  ds_read_b64_tr_b16 v[170:171], v6 offset:41984
  s_mov_b32 m0, s41
  v_mfma_f32_16x16x32_bf16 v[52:55], v[216:219], v[236:239], v[52:55]
  ds_read_b64_tr_b16 v[172:173], v7 offset:40960
  buffer_load_dwordx4 v3, s[24:27], s35 offen nt lds
  s_add_u32 s35, s35, 8192
  v_mfma_f32_16x16x32_bf16 v[56:59], v[216:219], v[240:243], v[56:59]
  ds_read_b64_tr_b16 v[174:175], v7 offset:41984
  v_mfma_f32_16x16x32_bf16 v[60:63], v[216:219], v[244:247], v[60:63]
  ds_read_b64_tr_b16 v[176:177], v8 offset:40960
  s_add_u32 m0, s38, 16896
  v_mfma_f32_16x16x32_bf16 v[64:67], v[220:223], v[236:239], v[64:67]
  ds_read_b64_tr_b16 v[178:179], v8 offset:41984
  buffer_load_dwordx4 v3, s[20:23], s32 offen nt lds
  s_add_u32 s32, s32, 8192
  v_mfma_f32_16x16x32_bf16 v[68:71], v[220:223], v[240:243], v[68:71]
  ds_read_b64_tr_b16 v[180:181], v9 offset:40960
  s_add_u32 m0, s39, 16896
  v_mfma_f32_16x16x32_bf16 v[72:75], v[220:223], v[244:247], v[72:75]
  ds_read_b64_tr_b16 v[182:183], v9 offset:41984
  buffer_load_dwordx4 v3, s[20:23], s33 offen nt lds
  s_add_u32 s33, s33, 8192
  v_mfma_f32_16x16x32_bf16 v[76:79], v[224:227], v[236:239], v[76:79]
  ds_read_b64_tr_b16 v[184:185], v10 offset:40960
  v_mfma_f32_16x16x32_bf16 v[80:83], v[224:227], v[240:243], v[80:83]
  ds_read_b64_tr_b16 v[186:187], v10 offset:41984
  s_add_u32 m0, s40, 16896
  v_mfma_f32_16x16x32_bf16 v[84:87], v[224:227], v[244:247], v[84:87]
  ds_read_b64_tr_b16 v[188:189], v11 offset:40960
  buffer_load_dwordx4 v3, s[24:27], s34 offen nt lds
  s_add_u32 s34, s34, 8192
  v_mfma_f32_16x16x32_bf16 v[88:91], v[228:231], v[236:239], v[88:91]
  ds_read_b64_tr_b16 v[190:191], v11 offset:41984
  v_mfma_f32_16x16x32_bf16 v[92:95], v[228:231], v[240:243], v[92:95]
  s_add_u32 m0, s41, 16896
  v_mfma_f32_16x16x32_bf16 v[96:99], v[228:231], v[244:247], v[96:99]
  buffer_load_dwordx4 v3, s[24:27], s35 offen nt lds
  s_add_u32 s35, s35, 8192
  v_mfma_f32_16x16x32_bf16 v[100:103], v[232:235], v[236:239], v[100:103]
  v_mfma_f32_16x16x32_bf16 v[104:107], v[232:235], v[240:243], v[104:107]
  v_mfma_f32_16x16x32_bf16 v[108:111], v[232:235], v[244:247], v[108:111]
  s_waitcnt lgkmcnt(14)
  v_mfma_f32_16x16x32_bf16 v[16:19], v[160:163], v[192:195], v[16:19]
  ds_read_b128 v[236:239], v15 offset:40960
  v_mfma_f32_16x16x32_bf16 v[20:23], v[160:163], v[196:199], v[20:23]
  ds_read_b128 v[240:243], v15 offset:43008
  v_mfma_f32_16x16x32_bf16 v[24:27], v[160:163], v[200:203], v[24:27]
  ds_read_b128 v[244:247], v15 offset:45056
  s_waitcnt lgkmcnt(15)
  v_mfma_f32_16x16x32_bf16 v[28:31], v[164:167], v[192:195], v[28:31]
  ds_read_b64_tr_b16 v[204:205], v4 offset:49152
  v_mfma_f32_16x16x32_bf16 v[32:35], v[164:167], v[196:199], v[32:35]
  ds_read_b64_tr_b16 v[206:207], v4 offset:50176
  v_mfma_f32_16x16x32_bf16 v[36:39], v[164:167], v[200:203], v[36:39]
  ds_read_b64_tr_b16 v[208:209], v5 offset:49152
  s_waitcnt lgkmcnt(15)
  v_mfma_f32_16x16x32_bf16 v[40:43], v[168:171], v[192:195], v[40:43]
  ds_read_b64_tr_b16 v[210:211], v5 offset:50176
  v_mfma_f32_16x16x32_bf16 v[44:47], v[168:171], v[196:199], v[44:47]
  ds_read_b64_tr_b16 v[212:213], v6 offset:49152
  v_mfma_f32_16x16x32_bf16 v[48:51], v[168:171], v[200:203], v[48:51]
  ds_read_b64_tr_b16 v[214:215], v6 offset:50176
  s_waitcnt lgkmcnt(15)
  v_mfma_f32_16x16x32_bf16 v[52:55], v[172:175], v[192:195], v[52:55]
  ds_read_b64_tr_b16 v[216:217], v7 offset:49152
  v_mfma_f32_16x16x32_bf16 v[56:59], v[172:175], v[196:199], v[56:59]
  ds_read_b64_tr_b16 v[218:219], v7 offset:50176
  v_mfma_f32_16x16x32_bf16 v[60:63], v[172:175], v[200:203], v[60:63]
  ds_read_b64_tr_b16 v[220:221], v8 offset:49152
  v_mfma_f32_16x16x32_bf16 v[64:67], v[176:179], v[192:195], v[64:67]
  ds_read_b64_tr_b16 v[222:223], v8 offset:50176
  v_mfma_f32_16x16x32_bf16 v[68:71], v[176:179], v[196:199], v[68:71]
  ds_read_b64_tr_b16 v[224:225], v9 offset:49152
  v_mfma_f32_16x16x32_bf16 v[72:75], v[176:179], v[200:203], v[72:75]
  ds_read_b64_tr_b16 v[226:227], v9 offset:50176
  s_waitcnt lgkmcnt(15)
  v_mfma_f32_16x16x32_bf16 v[76:79], v[180:183], v[192:195], v[76:79]
  ds_read_b64_tr_b16 v[228:229], v10 offset:49152
  v_mfma_f32_16x16x32_bf16 v[80:83], v[180:183], v[196:199], v[80:83]
  ds_read_b64_tr_b16 v[230:231], v10 offset:50176
  v_mfma_f32_16x16x32_bf16 v[84:87], v[180:183], v[200:203], v[84:87]
  ds_read_b64_tr_b16 v[232:233], v11 offset:49152
  v_mfma_f32_16x16x32_bf16 v[88:91], v[184:187], v[192:195], v[88:91]
  ds_read_b64_tr_b16 v[234:235], v11 offset:50176
  v_mfma_f32_16x16x32_bf16 v[92:95], v[184:187], v[196:199], v[92:95]
  v_mfma_f32_16x16x32_bf16 v[96:99], v[184:187], v[200:203], v[96:99]
  v_mfma_f32_16x16x32_bf16 v[100:103], v[188:191], v[192:195], v[100:103]
  v_mfma_f32_16x16x32_bf16 v[104:107], v[188:191], v[196:199], v[104:107]
  v_mfma_f32_16x16x32_bf16 v[108:111], v[188:191], v[200:203], v[108:111]
  s_waitcnt lgkmcnt(0)
  s_barrier
  v_mfma_f32_16x16x32_bf16 v[16:19], v[204:207], v[236:239], v[16:19]
  s_add_u32 m0, s38, 33792
  v_mfma_f32_16x16x32_bf16 v[20:23], v[204:207], v[240:243], v[20:23]
  buffer_load_dwordx4 v3, s[20:23], s32 offen nt lds
  s_add_u32 s32, s32, 8192
  v_mfma_f32_16x16x32_bf16 v[24:27], v[204:207], v[244:247], v[24:27]
  s_add_u32 m0, s39, 33792
  v_mfma_f32_16x16x32_bf16 v[28:31], v[208:211], v[236:239], v[28:31]
  buffer_load_dwordx4 v3, s[20:23], s33 offen nt lds
  s_add_u32 s33, s33, 8192
  v_mfma_f32_16x16x32_bf16 v[32:35], v[208:211], v[240:243], v[32:35]
  v_mfma_f32_16x16x32_bf16 v[36:39], v[208:211], v[244:247], v[36:39]
  s_add_u32 m0, s40, 33792
  v_mfma_f32_16x16x32_bf16 v[40:43], v[212:215], v[236:239], v[40:43]
  buffer_load_dwordx4 v3, s[24:27], s34 offen nt lds
  s_add_u32 s34, s34, 8192
  v_mfma_f32_16x16x32_bf16 v[44:47], v[212:215], v[240:243], v[44:47]
  v_mfma_f32_16x16x32_bf16 v[48:51], v[212:215], v[244:247], v[48:51]
  s_add_u32 m0, s41, 33792
  v_mfma_f32_16x16x32_bf16 v[52:55], v[216:219], v[236:239], v[52:55]
  buffer_load_dwordx4 v3, s[24:27], s35 offen nt lds
  s_add_u32 s35, s35, 8192
  v_mfma_f32_16x16x32_bf16 v[56:59], v[216:219], v[240:243], v[56:59]
  v_mfma_f32_16x16x32_bf16 v[60:63], v[216:219], v[244:247], v[60:63]
  s_add_u32 m0, s38, 50688
  v_mfma_f32_16x16x32_bf16 v[64:67], v[220:223], v[236:239], v[64:67]
  buffer_load_dwordx4 v3, s[20:23], s32 offen nt lds
  s_add_u32 s32, s32, 8192
  v_mfma_f32_16x16x32_bf16 v[68:71], v[220:223], v[240:243], v[68:71]
  s_add_u32 m0, s39, 50688
  v_mfma_f32_16x16x32_bf16 v[72:75], v[220:223], v[244:247], v[72:75]
  buffer_load_dwordx4 v3, s[20:23], s33 offen nt lds
  s_add_u32 s33, s33, 8192
  v_mfma_f32_16x16x32_bf16 v[76:79], v[224:227], v[236:239], v[76:79]
  v_mfma_f32_16x16x32_bf16 v[80:83], v[224:227], v[240:243], v[80:83]
  s_add_u32 m0, s40, 50688
  v_mfma_f32_16x16x32_bf16 v[84:87], v[224:227], v[244:247], v[84:87]
  buffer_load_dwordx4 v3, s[24:27], s34 offen nt lds
  s_add_u32 s34, s34, 8192
  v_mfma_f32_16x16x32_bf16 v[88:91], v[228:231], v[236:239], v[88:91]
  v_mfma_f32_16x16x32_bf16 v[92:95], v[228:231], v[240:243], v[92:95]
  s_add_u32 m0, s41, 50688
  v_mfma_f32_16x16x32_bf16 v[96:99], v[228:231], v[244:247], v[96:99]
  buffer_load_dwordx4 v3, s[24:27], s35 offen nt lds
  s_add_u32 s35, s35, 8192
  v_mfma_f32_16x16x32_bf16 v[100:103], v[232:235], v[236:239], v[100:103]
  v_mfma_f32_16x16x32_bf16 v[104:107], v[232:235], v[240:243], v[104:107]
  v_mfma_f32_16x16x32_bf16 v[108:111], v[232:235], v[244:247], v[108:111]
  s_waitcnt lgkmcnt(0)
  s_cmp_eq_u32 s79, 0
  s_cbranch_scc0 concat_heads__mha_block_cached__gqa_block_cached__near_ridge_kernel_h_apb
  s_setprio 1
  s_branch concat_heads__mha_block_cached__gqa_block_cached__near_ridge_kernel_h_apd
concat_heads__mha_block_cached__gqa_block_cached__near_ridge_kernel_h_apb:
  s_setprio 0
concat_heads__mha_block_cached__gqa_block_cached__near_ridge_kernel_h_apd:
  v_pk_mul_f32 v[16:17], v[16:17], s[50:51]
  v_pk_mul_f32 v[18:19], v[18:19], s[50:51]
  v_pk_mul_f32 v[28:29], v[28:29], s[50:51]
  v_pk_mul_f32 v[30:31], v[30:31], s[50:51]
  v_pk_mul_f32 v[40:41], v[40:41], s[50:51]
  v_pk_mul_f32 v[42:43], v[42:43], s[50:51]
  v_pk_mul_f32 v[52:53], v[52:53], s[50:51]
  v_pk_mul_f32 v[54:55], v[54:55], s[50:51]
  v_pk_mul_f32 v[64:65], v[64:65], s[50:51]
  v_pk_mul_f32 v[66:67], v[66:67], s[50:51]
  v_pk_mul_f32 v[76:77], v[76:77], s[50:51]
  v_pk_mul_f32 v[78:79], v[78:79], s[50:51]
  v_pk_mul_f32 v[88:89], v[88:89], s[50:51]
  v_pk_mul_f32 v[90:91], v[90:91], s[50:51]
  v_pk_mul_f32 v[100:101], v[100:101], s[50:51]
  v_pk_mul_f32 v[102:103], v[102:103], s[50:51]
  v_pk_mul_f32 v[20:21], v[20:21], s[50:51]
  v_pk_mul_f32 v[22:23], v[22:23], s[50:51]
  v_pk_mul_f32 v[32:33], v[32:33], s[50:51]
  v_pk_mul_f32 v[34:35], v[34:35], s[50:51]
  v_pk_mul_f32 v[44:45], v[44:45], s[50:51]
  v_pk_mul_f32 v[46:47], v[46:47], s[50:51]
  v_pk_mul_f32 v[56:57], v[56:57], s[50:51]
  v_pk_mul_f32 v[58:59], v[58:59], s[50:51]
  v_pk_mul_f32 v[68:69], v[68:69], s[50:51]
  v_pk_mul_f32 v[70:71], v[70:71], s[50:51]
  v_pk_mul_f32 v[80:81], v[80:81], s[50:51]
  v_pk_mul_f32 v[82:83], v[82:83], s[50:51]
  v_pk_mul_f32 v[92:93], v[92:93], s[50:51]
  v_pk_mul_f32 v[94:95], v[94:95], s[50:51]
  v_pk_mul_f32 v[104:105], v[104:105], s[50:51]
  v_pk_mul_f32 v[106:107], v[106:107], s[50:51]
  v_pk_mul_f32 v[24:25], v[24:25], s[50:51]
  v_pk_mul_f32 v[26:27], v[26:27], s[50:51]
  v_pk_mul_f32 v[36:37], v[36:37], s[50:51]
  v_pk_mul_f32 v[38:39], v[38:39], s[50:51]
  v_pk_mul_f32 v[48:49], v[48:49], s[50:51]
  v_pk_mul_f32 v[50:51], v[50:51], s[50:51]
  v_pk_mul_f32 v[60:61], v[60:61], s[50:51]
  v_pk_mul_f32 v[62:63], v[62:63], s[50:51]
  v_pk_mul_f32 v[72:73], v[72:73], s[50:51]
  v_pk_mul_f32 v[74:75], v[74:75], s[50:51]
  v_pk_mul_f32 v[84:85], v[84:85], s[50:51]
  v_pk_mul_f32 v[86:87], v[86:87], s[50:51]
  v_pk_mul_f32 v[96:97], v[96:97], s[50:51]
  v_pk_mul_f32 v[98:99], v[98:99], s[50:51]
  v_pk_mul_f32 v[108:109], v[108:109], s[50:51]
  v_pk_mul_f32 v[110:111], v[110:111], s[50:51]
  v_cvt_pk_bf16_f32 v112, v16, v17
  v_cvt_pk_bf16_f32 v113, v18, v19
  v_cvt_pk_bf16_f32 v114, v28, v29
  v_cvt_pk_bf16_f32 v115, v30, v31
  v_cvt_pk_bf16_f32 v116, v40, v41
  v_cvt_pk_bf16_f32 v117, v42, v43
  v_cvt_pk_bf16_f32 v118, v52, v53
  v_cvt_pk_bf16_f32 v119, v54, v55
  v_cvt_pk_bf16_f32 v120, v64, v65
  v_cvt_pk_bf16_f32 v121, v66, v67
  v_cvt_pk_bf16_f32 v122, v76, v77
  v_cvt_pk_bf16_f32 v123, v78, v79
  v_cvt_pk_bf16_f32 v124, v88, v89
  v_cvt_pk_bf16_f32 v125, v90, v91
  v_cvt_pk_bf16_f32 v126, v100, v101
  v_cvt_pk_bf16_f32 v127, v102, v103
  v_cvt_pk_bf16_f32 v128, v20, v21
  v_cvt_pk_bf16_f32 v129, v22, v23
  v_cvt_pk_bf16_f32 v130, v32, v33
  v_cvt_pk_bf16_f32 v131, v34, v35
  v_cvt_pk_bf16_f32 v132, v44, v45
  v_cvt_pk_bf16_f32 v133, v46, v47
  v_cvt_pk_bf16_f32 v134, v56, v57
  v_cvt_pk_bf16_f32 v135, v58, v59
  v_cvt_pk_bf16_f32 v136, v68, v69
  v_cvt_pk_bf16_f32 v137, v70, v71
  v_cvt_pk_bf16_f32 v138, v80, v81
  v_cvt_pk_bf16_f32 v139, v82, v83
  v_cvt_pk_bf16_f32 v140, v92, v93
  v_cvt_pk_bf16_f32 v141, v94, v95
  v_cvt_pk_bf16_f32 v142, v104, v105
  v_cvt_pk_bf16_f32 v143, v106, v107
  v_cvt_pk_bf16_f32 v144, v24, v25
  v_cvt_pk_bf16_f32 v145, v26, v27
  v_cvt_pk_bf16_f32 v146, v36, v37
  v_cvt_pk_bf16_f32 v147, v38, v39
  v_cvt_pk_bf16_f32 v148, v48, v49
  v_cvt_pk_bf16_f32 v149, v50, v51
  v_cvt_pk_bf16_f32 v150, v60, v61
  v_cvt_pk_bf16_f32 v151, v62, v63
  v_cvt_pk_bf16_f32 v152, v72, v73
  v_cvt_pk_bf16_f32 v153, v74, v75
  v_cvt_pk_bf16_f32 v154, v84, v85
  v_cvt_pk_bf16_f32 v155, v86, v87
  v_cvt_pk_bf16_f32 v156, v96, v97
  v_cvt_pk_bf16_f32 v157, v98, v99
  v_cvt_pk_bf16_f32 v158, v108, v109
  v_cvt_pk_bf16_f32 v159, v110, v111
  v_permlane16_swap_b32 v112, v114
  v_permlane16_swap_b32 v113, v115
  v_permlane16_swap_b32 v116, v118
  v_permlane16_swap_b32 v117, v119
  v_permlane16_swap_b32 v120, v122
  v_permlane16_swap_b32 v121, v123
  v_permlane16_swap_b32 v124, v126
  v_permlane16_swap_b32 v125, v127
  v_permlane16_swap_b32 v128, v130
  v_permlane16_swap_b32 v129, v131
  v_permlane16_swap_b32 v132, v134
  v_permlane16_swap_b32 v133, v135
  v_permlane16_swap_b32 v136, v138
  v_permlane16_swap_b32 v137, v139
  v_permlane16_swap_b32 v140, v142
  v_permlane16_swap_b32 v141, v143
  v_permlane16_swap_b32 v144, v146
  v_permlane16_swap_b32 v145, v147
  v_permlane16_swap_b32 v148, v150
  v_permlane16_swap_b32 v149, v151
  v_permlane16_swap_b32 v152, v154
  v_permlane16_swap_b32 v153, v155
  v_permlane16_swap_b32 v156, v158
  v_permlane16_swap_b32 v157, v159
  v_mov_b32 v16, 0
  v_mov_b32 v17, 0
  v_mov_b32 v18, 0
  v_mov_b32 v19, 0
  v_mov_b32 v20, 0
  v_mov_b32 v21, 0
  v_mov_b32 v22, 0
  v_mov_b32 v23, 0
  v_mov_b32 v24, 0
  v_mov_b32 v25, 0
  v_mov_b32 v26, 0
  v_mov_b32 v27, 0
  v_mov_b32 v28, 0
  v_mov_b32 v29, 0
  v_mov_b32 v30, 0
  v_mov_b32 v31, 0
  v_mov_b32 v32, 0
  v_mov_b32 v33, 0
  v_mov_b32 v34, 0
  v_mov_b32 v35, 0
  v_mov_b32 v36, 0
  v_mov_b32 v37, 0
  v_mov_b32 v38, 0
  v_mov_b32 v39, 0
  v_mov_b32 v40, 0
  v_mov_b32 v41, 0
  v_mov_b32 v42, 0
  v_mov_b32 v43, 0
  v_mov_b32 v44, 0
  v_mov_b32 v45, 0
  v_mov_b32 v46, 0
  v_mov_b32 v47, 0
  v_mov_b32 v48, 0
  v_mov_b32 v49, 0
  v_mov_b32 v50, 0
  v_mov_b32 v51, 0
  v_mov_b32 v52, 0
  v_mov_b32 v53, 0
  v_mov_b32 v54, 0
  v_mov_b32 v55, 0
  v_mov_b32 v56, 0
  v_mov_b32 v57, 0
  v_mov_b32 v58, 0
  v_mov_b32 v59, 0
  v_mov_b32 v60, 0
  v_mov_b32 v61, 0
  v_mov_b32 v62, 0
  v_mov_b32 v63, 0
  v_mov_b32 v64, 0
  v_mov_b32 v65, 0
  v_mov_b32 v66, 0
  v_mov_b32 v67, 0
  v_mov_b32 v68, 0
  v_mov_b32 v69, 0
  v_mov_b32 v70, 0
  v_mov_b32 v71, 0
  v_mov_b32 v72, 0
  v_mov_b32 v73, 0
  v_mov_b32 v74, 0
  v_mov_b32 v75, 0
  v_mov_b32 v76, 0
  v_mov_b32 v77, 0
  v_mov_b32 v78, 0
  v_mov_b32 v79, 0
  v_mov_b32 v80, 0
  v_mov_b32 v81, 0
  v_mov_b32 v82, 0
  v_mov_b32 v83, 0
  v_mov_b32 v84, 0
  v_mov_b32 v85, 0
  v_mov_b32 v86, 0
  v_mov_b32 v87, 0
  v_mov_b32 v88, 0
  v_mov_b32 v89, 0
  v_mov_b32 v90, 0
  v_mov_b32 v91, 0
  v_mov_b32 v92, 0
  v_mov_b32 v93, 0
  v_mov_b32 v94, 0
  v_mov_b32 v95, 0
  v_mov_b32 v96, 0
  v_mov_b32 v97, 0
  v_mov_b32 v98, 0
  v_mov_b32 v99, 0
  v_mov_b32 v100, 0
  v_mov_b32 v101, 0
  v_mov_b32 v102, 0
  v_mov_b32 v103, 0
  v_mov_b32 v104, 0
  v_mov_b32 v105, 0
  v_mov_b32 v106, 0
  v_mov_b32 v107, 0
  v_mov_b32 v108, 0
  v_mov_b32 v109, 0
  v_mov_b32 v110, 0
  v_mov_b32 v111, 0
  v_mov_b32 v4, 0
  v_mov_b32 v5, 0
  v_mov_b32 v6, 0
  s_sub_u32 s34, s34, 8192
  s_sub_u32 s35, s35, 8192
  s_waitcnt vmcnt(14)
  s_barrier
  ds_read_b128 v[214:217], v13 offset:0
  ds_read_b128 v[218:221], v13 offset:64
  ds_read_b128 v[222:225], v13 offset:128
  s_waitcnt lgkmcnt(2)
  v_mfma_f32_16x16x32_bf16 v[160:163], v[214:217], v[112:115], 0
  ds_read_b128 v[226:229], v13 offset:192
  v_mfma_f32_16x16x32_bf16 v[164:167], v[214:217], v[128:131], 0
  v_mfma_f32_16x16x32_bf16 v[168:171], v[214:217], v[144:147], 0
  s_waitcnt lgkmcnt(2)
  v_mfma_f32_16x16x32_bf16 v[160:163], v[218:221], v[116:119], v[160:163]
  ds_read_b128 v[214:217], v13 offset:512
  v_mfma_f32_16x16x32_bf16 v[164:167], v[218:221], v[132:135], v[164:167]
  v_mfma_f32_16x16x32_bf16 v[168:171], v[218:221], v[148:151], v[168:171]
  s_waitcnt lgkmcnt(2)
  v_mfma_f32_16x16x32_bf16 v[160:163], v[222:225], v[120:123], v[160:163]
  ds_read_b128 v[218:221], v13 offset:576
  v_mfma_f32_16x16x32_bf16 v[164:167], v[222:225], v[136:139], v[164:167]
  v_mfma_f32_16x16x32_bf16 v[168:171], v[222:225], v[152:155], v[168:171]
  s_waitcnt lgkmcnt(2)
  v_mfma_f32_16x16x32_bf16 v[160:163], v[226:229], v[124:127], v[160:163]
  ds_read_b128 v[222:225], v13 offset:640
  v_mfma_f32_16x16x32_bf16 v[164:167], v[226:229], v[140:143], v[164:167]
  v_mfma_f32_16x16x32_bf16 v[168:171], v[226:229], v[156:159], v[168:171]
  s_waitcnt lgkmcnt(2)
  v_mfma_f32_16x16x32_bf16 v[172:175], v[214:217], v[112:115], 0
  ds_read_b128 v[226:229], v13 offset:704
  v_mfma_f32_16x16x32_bf16 v[176:179], v[214:217], v[128:131], 0
  v_mfma_f32_16x16x32_bf16 v[180:183], v[214:217], v[144:147], 0
  s_waitcnt lgkmcnt(2)
  v_mfma_f32_16x16x32_bf16 v[172:175], v[218:221], v[116:119], v[172:175]
  v_mfma_f32_16x16x32_bf16 v[176:179], v[218:221], v[132:135], v[176:179]
  v_mfma_f32_16x16x32_bf16 v[180:183], v[218:221], v[148:151], v[180:183]
  s_waitcnt lgkmcnt(1)
  v_mfma_f32_16x16x32_bf16 v[172:175], v[222:225], v[120:123], v[172:175]
  v_mfma_f32_16x16x32_bf16 v[176:179], v[222:225], v[136:139], v[176:179]
  v_mfma_f32_16x16x32_bf16 v[180:183], v[222:225], v[152:155], v[180:183]
  s_waitcnt lgkmcnt(0)
  v_mfma_f32_16x16x32_bf16 v[172:175], v[226:229], v[124:127], v[172:175]
  v_mfma_f32_16x16x32_bf16 v[176:179], v[226:229], v[140:143], v[176:179]
  v_mfma_f32_16x16x32_bf16 v[180:183], v[226:229], v[156:159], v[180:183]
  s_waitcnt vmcnt(8) lgkmcnt(0)
  s_barrier
  ds_read_b128 v[214:217], v13 offset:16896
  ds_read_b128 v[218:221], v13 offset:16960
  ds_read_b128 v[222:225], v13 offset:17024
  v_exp_f32 v160, v160
  v_exp_f32 v161, v161
  v_exp_f32 v162, v162
  v_exp_f32 v163, v163
  v_exp_f32 v164, v164
  v_add_f32 v4, v4, v160
  v_cvt_pk_bf16_f32 v196, v160, v161
  v_exp_f32 v165, v165
  v_add_f32 v4, v4, v161
  v_exp_f32 v166, v166
  v_add_f32 v4, v4, v162
  v_cvt_pk_bf16_f32 v197, v162, v163
  v_exp_f32 v167, v167
  v_add_f32 v4, v4, v163
  v_exp_f32 v168, v168
  v_add_f32 v5, v5, v164
  v_cvt_pk_bf16_f32 v202, v164, v165
  v_exp_f32 v169, v169
  v_add_f32 v5, v5, v165
  v_exp_f32 v170, v170
  v_add_f32 v5, v5, v166
  v_cvt_pk_bf16_f32 v203, v166, v167
  v_exp_f32 v171, v171
  v_add_f32 v5, v5, v167
  v_add_f32 v6, v6, v168
  v_cvt_pk_bf16_f32 v208, v168, v169
  v_add_f32 v6, v6, v169
  v_add_f32 v6, v6, v170
  v_cvt_pk_bf16_f32 v209, v170, v171
  v_add_f32 v6, v6, v171
  s_mov_b32 s42, 4
concat_heads__mha_block_cached__gqa_block_cached__near_ridge_kernel_h_aloop:
  s_waitcnt lgkmcnt(2)
  v_mfma_f32_16x16x32_bf16 v[160:163], v[214:217], v[112:115], 0
  ds_read_b128 v[226:229], v13 offset:17088
  v_exp_f32 v172, v172
  v_exp_f32 v173, v173
  v_mfma_f32_16x16x32_bf16 v[164:167], v[214:217], v[128:131], 0
  v_exp_f32 v174, v174
  v_mfma_f32_16x16x32_bf16 v[168:171], v[214:217], v[144:147], 0
  v_exp_f32 v175, v175
  s_waitcnt lgkmcnt(2)
  v_mfma_f32_16x16x32_bf16 v[160:163], v[218:221], v[116:119], v[160:163]
  ds_read_b128 v[214:217], v13 offset:17408
  v_exp_f32 v176, v176
  v_add_f32 v4, v4, v172
  v_mfma_f32_16x16x32_bf16 v[164:167], v[218:221], v[132:135], v[164:167]
  v_cvt_pk_bf16_f32 v198, v172, v173
  v_mfma_f32_16x16x32_bf16 v[168:171], v[218:221], v[148:151], v[168:171]
  v_exp_f32 v177, v177
  s_waitcnt lgkmcnt(2)
  v_mfma_f32_16x16x32_bf16 v[160:163], v[222:225], v[120:123], v[160:163]
  ds_read_b128 v[218:221], v13 offset:17472
  v_add_f32 v4, v4, v173
  v_exp_f32 v178, v178
  v_mfma_f32_16x16x32_bf16 v[164:167], v[222:225], v[136:139], v[164:167]
  v_add_f32 v4, v4, v174
  v_mfma_f32_16x16x32_bf16 v[168:171], v[222:225], v[152:155], v[168:171]
  v_cvt_pk_bf16_f32 v199, v174, v175
  s_waitcnt lgkmcnt(2)
  v_mfma_f32_16x16x32_bf16 v[160:163], v[226:229], v[124:127], v[160:163]
  ds_read_b128 v[222:225], v13 offset:17536
  v_exp_f32 v179, v179
  v_add_f32 v4, v4, v175
  v_mfma_f32_16x16x32_bf16 v[164:167], v[226:229], v[140:143], v[164:167]
  v_exp_f32 v180, v180
  v_mfma_f32_16x16x32_bf16 v[168:171], v[226:229], v[156:159], v[168:171]
  v_add_f32 v5, v5, v176
  s_waitcnt lgkmcnt(2)
  v_mfma_f32_16x16x32_bf16 v[184:187], v[214:217], v[112:115], 0
  ds_read_b128 v[226:229], v13 offset:17600
  v_cvt_pk_bf16_f32 v204, v176, v177
  v_mfma_f32_16x16x32_bf16 v[188:191], v[214:217], v[128:131], 0
  v_exp_f32 v181, v181
  v_add_f32 v5, v5, v177
  v_mfma_f32_16x16x32_bf16 v[192:195], v[214:217], v[144:147], 0
  ds_read_b64_tr_b16 v[230:231], v14 offset:0
  v_exp_f32 v182, v182
  s_waitcnt lgkmcnt(3)
  v_mfma_f32_16x16x32_bf16 v[184:187], v[218:221], v[116:119], v[184:187]
  ds_read_b64_tr_b16 v[232:233], v14 offset:512
  v_add_f32 v5, v5, v178
  v_mfma_f32_16x16x32_bf16 v[188:191], v[218:221], v[132:135], v[188:191]
  ds_read_b64_tr_b16 v[234:235], v14 offset:32
  v_cvt_pk_bf16_f32 v205, v178, v179
  v_exp_f32 v183, v183
  v_mfma_f32_16x16x32_bf16 v[192:195], v[218:221], v[148:151], v[192:195]
  ds_read_b64_tr_b16 v[236:237], v14 offset:544
  v_add_f32 v5, v5, v179
  s_waitcnt lgkmcnt(5)
  v_mfma_f32_16x16x32_bf16 v[184:187], v[222:225], v[120:123], v[184:187]
  ds_read_b64_tr_b16 v[238:239], v14 offset:64
  v_add_f32 v6, v6, v180
  v_mfma_f32_16x16x32_bf16 v[188:191], v[222:225], v[136:139], v[188:191]
  ds_read_b64_tr_b16 v[240:241], v14 offset:576
  v_cvt_pk_bf16_f32 v210, v180, v181
  v_add_f32 v6, v6, v181
  v_mfma_f32_16x16x32_bf16 v[192:195], v[222:225], v[152:155], v[192:195]
  ds_read_b64_tr_b16 v[242:243], v14 offset:96
  v_add_f32 v6, v6, v182
  s_waitcnt lgkmcnt(7)
  v_mfma_f32_16x16x32_bf16 v[184:187], v[226:229], v[124:127], v[184:187]
  ds_read_b64_tr_b16 v[244:245], v14 offset:608
  v_cvt_pk_bf16_f32 v211, v182, v183
  v_mfma_f32_16x16x32_bf16 v[188:191], v[226:229], v[140:143], v[188:191]
  v_add_f32 v6, v6, v183
  v_mfma_f32_16x16x32_bf16 v[192:195], v[226:229], v[156:159], v[192:195]
  s_waitcnt lgkmcnt(6)
  v_mfma_f32_16x16x32_bf16 v[16:19], v[230:233], v[196:199], v[16:19]
  v_exp_f32 v160, v160
  v_exp_f32 v161, v161
  v_mfma_f32_16x16x32_bf16 v[20:23], v[230:233], v[202:205], v[20:23]
  v_exp_f32 v162, v162
  v_mfma_f32_16x16x32_bf16 v[24:27], v[230:233], v[208:211], v[24:27]
  ds_read_b64_tr_b16 v[230:231], v14 offset:128
  v_exp_f32 v163, v163
  s_waitcnt lgkmcnt(5)
  v_mfma_f32_16x16x32_bf16 v[28:31], v[234:237], v[196:199], v[28:31]
  ds_read_b64_tr_b16 v[232:233], v14 offset:640
  v_exp_f32 v164, v164
  v_add_f32 v4, v4, v160
  v_mfma_f32_16x16x32_bf16 v[32:35], v[234:237], v[202:205], v[32:35]
  v_cvt_pk_bf16_f32 v200, v160, v161
  v_mfma_f32_16x16x32_bf16 v[36:39], v[234:237], v[208:211], v[36:39]
  ds_read_b64_tr_b16 v[234:235], v14 offset:160
  v_exp_f32 v165, v165
  s_waitcnt lgkmcnt(5)
  v_mfma_f32_16x16x32_bf16 v[40:43], v[238:241], v[196:199], v[40:43]
  ds_read_b64_tr_b16 v[236:237], v14 offset:672
  v_add_f32 v4, v4, v161
  v_exp_f32 v166, v166
  v_mfma_f32_16x16x32_bf16 v[44:47], v[238:241], v[202:205], v[44:47]
  v_add_f32 v4, v4, v162
  v_mfma_f32_16x16x32_bf16 v[48:51], v[238:241], v[208:211], v[48:51]
  ds_read_b64_tr_b16 v[238:239], v14 offset:192
  v_cvt_pk_bf16_f32 v201, v162, v163
  s_waitcnt lgkmcnt(5)
  v_mfma_f32_16x16x32_bf16 v[52:55], v[242:245], v[196:199], v[52:55]
  ds_read_b64_tr_b16 v[240:241], v14 offset:704
  v_exp_f32 v167, v167
  v_add_f32 v4, v4, v163
  v_mfma_f32_16x16x32_bf16 v[56:59], v[242:245], v[202:205], v[56:59]
  v_exp_f32 v168, v168
  v_mfma_f32_16x16x32_bf16 v[60:63], v[242:245], v[208:211], v[60:63]
  ds_read_b64_tr_b16 v[242:243], v14 offset:224
  v_add_f32 v5, v5, v164
  s_waitcnt lgkmcnt(5)
  v_mfma_f32_16x16x32_bf16 v[64:67], v[230:233], v[196:199], v[64:67]
  ds_read_b64_tr_b16 v[244:245], v14 offset:736
  v_cvt_pk_bf16_f32 v206, v164, v165
  v_mfma_f32_16x16x32_bf16 v[68:71], v[230:233], v[202:205], v[68:71]
  v_exp_f32 v169, v169
  v_add_f32 v5, v5, v165
  v_mfma_f32_16x16x32_bf16 v[72:75], v[230:233], v[208:211], v[72:75]
  v_exp_f32 v170, v170
  s_waitcnt lgkmcnt(4)
  v_mfma_f32_16x16x32_bf16 v[76:79], v[234:237], v[196:199], v[76:79]
  v_add_f32 v5, v5, v166
  v_mfma_f32_16x16x32_bf16 v[80:83], v[234:237], v[202:205], v[80:83]
  v_cvt_pk_bf16_f32 v207, v166, v167
  v_exp_f32 v171, v171
  s_waitcnt vmcnt(0) lgkmcnt(0)
  s_barrier
  s_mov_b32 m0, s38
  s_nop 0
  buffer_load_dwordx4 v3, s[20:23], s32 offen nt lds
  s_add_u32 s32, s32, 8192
  v_mfma_f32_16x16x32_bf16 v[84:87], v[234:237], v[208:211], v[84:87]
  v_add_f32 v5, v5, v167
  s_mov_b32 m0, s39
  s_nop 0
  buffer_load_dwordx4 v3, s[20:23], s33 offen nt lds
  s_add_u32 s33, s33, 8192
  ds_read_b128 v[214:217], v13 offset:33792
  v_mfma_f32_16x16x32_bf16 v[88:91], v[238:241], v[196:199], v[88:91]
  v_add_f32 v6, v6, v168
  s_add_u32 m0, s40, 50688
  s_nop 0
  buffer_load_dwordx4 v3, s[24:27], s34 offen nt lds
  s_add_u32 s34, s34, 8192
  ds_read_b128 v[218:221], v13 offset:33856
  v_mfma_f32_16x16x32_bf16 v[92:95], v[238:241], v[202:205], v[92:95]
  v_cvt_pk_bf16_f32 v212, v168, v169
  v_add_f32 v6, v6, v169
  s_add_u32 m0, s41, 50688
  s_nop 0
  buffer_load_dwordx4 v3, s[24:27], s35 offen nt lds
  s_add_u32 s35, s35, 8192
  ds_read_b128 v[222:225], v13 offset:33920
  v_mfma_f32_16x16x32_bf16 v[96:99], v[238:241], v[208:211], v[96:99]
  v_add_f32 v6, v6, v170
  s_add_u32 m0, s38, 16896
  s_nop 0
  buffer_load_dwordx4 v3, s[20:23], s32 offen nt lds
  s_add_u32 s32, s32, 8192
  v_mfma_f32_16x16x32_bf16 v[100:103], v[242:245], v[196:199], v[100:103]
  v_cvt_pk_bf16_f32 v213, v170, v171
  s_add_u32 m0, s39, 16896
  s_nop 0
  buffer_load_dwordx4 v3, s[20:23], s33 offen nt lds
  s_add_u32 s33, s33, 8192
  v_mfma_f32_16x16x32_bf16 v[104:107], v[242:245], v[202:205], v[104:107]
  v_add_f32 v6, v6, v171
  s_mov_b32 m0, s40
  s_nop 0
  buffer_load_dwordx4 v3, s[24:27], s34 offen nt lds
  s_add_u32 s34, s34, 8192
  v_mfma_f32_16x16x32_bf16 v[108:111], v[242:245], v[208:211], v[108:111]
  s_mov_b32 m0, s41
  s_nop 0
  buffer_load_dwordx4 v3, s[24:27], s35 offen nt lds
  s_add_u32 s35, s35, 8192
  s_waitcnt lgkmcnt(2)
  v_mfma_f32_16x16x32_bf16 v[160:163], v[214:217], v[112:115], 0
  ds_read_b128 v[226:229], v13 offset:33984
  v_exp_f32 v184, v184
  v_exp_f32 v185, v185
  v_mfma_f32_16x16x32_bf16 v[164:167], v[214:217], v[128:131], 0
  v_exp_f32 v186, v186
  v_mfma_f32_16x16x32_bf16 v[168:171], v[214:217], v[144:147], 0
  v_exp_f32 v187, v187
  s_waitcnt lgkmcnt(2)
  v_mfma_f32_16x16x32_bf16 v[160:163], v[218:221], v[116:119], v[160:163]
  ds_read_b128 v[214:217], v13 offset:34304
  v_exp_f32 v188, v188
  v_add_f32 v4, v4, v184
  v_mfma_f32_16x16x32_bf16 v[164:167], v[218:221], v[132:135], v[164:167]
  v_cvt_pk_bf16_f32 v198, v184, v185
  v_mfma_f32_16x16x32_bf16 v[168:171], v[218:221], v[148:151], v[168:171]
  v_exp_f32 v189, v189
  s_waitcnt lgkmcnt(2)
  v_mfma_f32_16x16x32_bf16 v[160:163], v[222:225], v[120:123], v[160:163]
  ds_read_b128 v[218:221], v13 offset:34368
  v_add_f32 v4, v4, v185
  v_exp_f32 v190, v190
  v_mfma_f32_16x16x32_bf16 v[164:167], v[222:225], v[136:139], v[164:167]
  v_add_f32 v4, v4, v186
  v_mfma_f32_16x16x32_bf16 v[168:171], v[222:225], v[152:155], v[168:171]
  v_cvt_pk_bf16_f32 v199, v186, v187
  s_waitcnt lgkmcnt(2)
  v_mfma_f32_16x16x32_bf16 v[160:163], v[226:229], v[124:127], v[160:163]
  ds_read_b128 v[222:225], v13 offset:34432
  v_exp_f32 v191, v191
  v_add_f32 v4, v4, v187
  v_mfma_f32_16x16x32_bf16 v[164:167], v[226:229], v[140:143], v[164:167]
  v_exp_f32 v192, v192
  v_mfma_f32_16x16x32_bf16 v[168:171], v[226:229], v[156:159], v[168:171]
  v_add_f32 v5, v5, v188
  s_waitcnt lgkmcnt(2)
  v_mfma_f32_16x16x32_bf16 v[172:175], v[214:217], v[112:115], 0
  ds_read_b128 v[226:229], v13 offset:34496
  v_cvt_pk_bf16_f32 v204, v188, v189
  v_mfma_f32_16x16x32_bf16 v[176:179], v[214:217], v[128:131], 0
  v_exp_f32 v193, v193
  v_add_f32 v5, v5, v189
  v_mfma_f32_16x16x32_bf16 v[180:183], v[214:217], v[144:147], 0
  ds_read_b64_tr_b16 v[232:233], v14 offset:16896
  v_exp_f32 v194, v194
  s_waitcnt lgkmcnt(3)
  v_mfma_f32_16x16x32_bf16 v[172:175], v[218:221], v[116:119], v[172:175]
  ds_read_b64_tr_b16 v[230:231], v14 offset:17408
  v_add_f32 v5, v5, v190
  v_mfma_f32_16x16x32_bf16 v[176:179], v[218:221], v[132:135], v[176:179]
  ds_read_b64_tr_b16 v[236:237], v14 offset:16928
  v_cvt_pk_bf16_f32 v205, v190, v191
  v_exp_f32 v195, v195
  v_mfma_f32_16x16x32_bf16 v[180:183], v[218:221], v[148:151], v[180:183]
  ds_read_b64_tr_b16 v[234:235], v14 offset:17440
  v_add_f32 v5, v5, v191
  s_waitcnt lgkmcnt(5)
  v_mfma_f32_16x16x32_bf16 v[172:175], v[222:225], v[120:123], v[172:175]
  ds_read_b64_tr_b16 v[240:241], v14 offset:16960
  v_add_f32 v6, v6, v192
  v_mfma_f32_16x16x32_bf16 v[176:179], v[222:225], v[136:139], v[176:179]
  ds_read_b64_tr_b16 v[238:239], v14 offset:17472
  v_cvt_pk_bf16_f32 v210, v192, v193
  v_add_f32 v6, v6, v193
  v_mfma_f32_16x16x32_bf16 v[180:183], v[222:225], v[152:155], v[180:183]
  ds_read_b64_tr_b16 v[244:245], v14 offset:16992
  v_add_f32 v6, v6, v194
  s_waitcnt lgkmcnt(7)
  v_mfma_f32_16x16x32_bf16 v[172:175], v[226:229], v[124:127], v[172:175]
  ds_read_b64_tr_b16 v[242:243], v14 offset:17504
  v_cvt_pk_bf16_f32 v211, v194, v195
  v_mfma_f32_16x16x32_bf16 v[176:179], v[226:229], v[140:143], v[176:179]
  v_add_f32 v6, v6, v195
  v_mfma_f32_16x16x32_bf16 v[180:183], v[226:229], v[156:159], v[180:183]
  s_waitcnt lgkmcnt(6)
  v_mfma_f32_16x16x32_bf16 v[16:19], v[230:233], v[198:201], v[16:19]
  v_exp_f32 v160, v160
  v_exp_f32 v161, v161
  v_mfma_f32_16x16x32_bf16 v[20:23], v[230:233], v[204:207], v[20:23]
  v_exp_f32 v162, v162
  v_mfma_f32_16x16x32_bf16 v[24:27], v[230:233], v[210:213], v[24:27]
  ds_read_b64_tr_b16 v[232:233], v14 offset:17024
  v_exp_f32 v163, v163
  s_waitcnt lgkmcnt(5)
  v_mfma_f32_16x16x32_bf16 v[28:31], v[234:237], v[198:201], v[28:31]
  ds_read_b64_tr_b16 v[230:231], v14 offset:17536
  v_exp_f32 v164, v164
  v_add_f32 v4, v4, v160
  v_mfma_f32_16x16x32_bf16 v[32:35], v[234:237], v[204:207], v[32:35]
  v_cvt_pk_bf16_f32 v196, v160, v161
  v_mfma_f32_16x16x32_bf16 v[36:39], v[234:237], v[210:213], v[36:39]
  ds_read_b64_tr_b16 v[236:237], v14 offset:17056
  v_exp_f32 v165, v165
  s_waitcnt lgkmcnt(5)
  v_mfma_f32_16x16x32_bf16 v[40:43], v[238:241], v[198:201], v[40:43]
  ds_read_b64_tr_b16 v[234:235], v14 offset:17568
  v_add_f32 v4, v4, v161
  v_exp_f32 v166, v166
  v_mfma_f32_16x16x32_bf16 v[44:47], v[238:241], v[204:207], v[44:47]
  v_add_f32 v4, v4, v162
  v_mfma_f32_16x16x32_bf16 v[48:51], v[238:241], v[210:213], v[48:51]
  ds_read_b64_tr_b16 v[240:241], v14 offset:17088
  v_cvt_pk_bf16_f32 v197, v162, v163
  s_waitcnt lgkmcnt(5)
  v_mfma_f32_16x16x32_bf16 v[52:55], v[242:245], v[198:201], v[52:55]
  ds_read_b64_tr_b16 v[238:239], v14 offset:17600
  v_exp_f32 v167, v167
  v_add_f32 v4, v4, v163
  v_mfma_f32_16x16x32_bf16 v[56:59], v[242:245], v[204:207], v[56:59]
  v_exp_f32 v168, v168
  v_mfma_f32_16x16x32_bf16 v[60:63], v[242:245], v[210:213], v[60:63]
  ds_read_b64_tr_b16 v[244:245], v14 offset:17120
  v_add_f32 v5, v5, v164
  s_waitcnt lgkmcnt(5)
  v_mfma_f32_16x16x32_bf16 v[64:67], v[230:233], v[198:201], v[64:67]
  ds_read_b64_tr_b16 v[242:243], v14 offset:17632
  v_cvt_pk_bf16_f32 v202, v164, v165
  v_mfma_f32_16x16x32_bf16 v[68:71], v[230:233], v[204:207], v[68:71]
  v_exp_f32 v169, v169
  v_add_f32 v5, v5, v165
  v_mfma_f32_16x16x32_bf16 v[72:75], v[230:233], v[210:213], v[72:75]
  v_exp_f32 v170, v170
  s_waitcnt lgkmcnt(4)
  v_mfma_f32_16x16x32_bf16 v[76:79], v[234:237], v[198:201], v[76:79]
  v_add_f32 v5, v5, v166
  v_mfma_f32_16x16x32_bf16 v[80:83], v[234:237], v[204:207], v[80:83]
  v_cvt_pk_bf16_f32 v203, v166, v167
  v_exp_f32 v171, v171
  v_mfma_f32_16x16x32_bf16 v[84:87], v[234:237], v[210:213], v[84:87]
  v_add_f32 v5, v5, v167
  ds_read_b128 v[214:217], v13 offset:50688
  s_waitcnt lgkmcnt(3)
  v_mfma_f32_16x16x32_bf16 v[88:91], v[238:241], v[198:201], v[88:91]
  v_add_f32 v6, v6, v168
  ds_read_b128 v[218:221], v13 offset:50752
  v_mfma_f32_16x16x32_bf16 v[92:95], v[238:241], v[204:207], v[92:95]
  v_cvt_pk_bf16_f32 v208, v168, v169
  v_add_f32 v6, v6, v169
  ds_read_b128 v[222:225], v13 offset:50816
  v_mfma_f32_16x16x32_bf16 v[96:99], v[238:241], v[210:213], v[96:99]
  v_add_f32 v6, v6, v170
  s_waitcnt lgkmcnt(3)
  v_mfma_f32_16x16x32_bf16 v[100:103], v[242:245], v[198:201], v[100:103]
  v_cvt_pk_bf16_f32 v209, v170, v171
  v_mfma_f32_16x16x32_bf16 v[104:107], v[242:245], v[204:207], v[104:107]
  v_add_f32 v6, v6, v171
  v_mfma_f32_16x16x32_bf16 v[108:111], v[242:245], v[210:213], v[108:111]
  s_waitcnt lgkmcnt(2)
  v_mfma_f32_16x16x32_bf16 v[160:163], v[214:217], v[112:115], 0
  ds_read_b128 v[226:229], v13 offset:50880
  v_exp_f32 v172, v172
  v_exp_f32 v173, v173
  v_mfma_f32_16x16x32_bf16 v[164:167], v[214:217], v[128:131], 0
  v_exp_f32 v174, v174
  v_mfma_f32_16x16x32_bf16 v[168:171], v[214:217], v[144:147], 0
  v_exp_f32 v175, v175
  s_waitcnt lgkmcnt(2)
  v_mfma_f32_16x16x32_bf16 v[160:163], v[218:221], v[116:119], v[160:163]
  ds_read_b128 v[214:217], v13 offset:51200
  v_exp_f32 v176, v176
  v_add_f32 v4, v4, v172
  v_mfma_f32_16x16x32_bf16 v[164:167], v[218:221], v[132:135], v[164:167]
  v_cvt_pk_bf16_f32 v198, v172, v173
  v_mfma_f32_16x16x32_bf16 v[168:171], v[218:221], v[148:151], v[168:171]
  v_exp_f32 v177, v177
  s_waitcnt lgkmcnt(2)
  v_mfma_f32_16x16x32_bf16 v[160:163], v[222:225], v[120:123], v[160:163]
  ds_read_b128 v[218:221], v13 offset:51264
  v_add_f32 v4, v4, v173
  v_exp_f32 v178, v178
  v_mfma_f32_16x16x32_bf16 v[164:167], v[222:225], v[136:139], v[164:167]
  v_add_f32 v4, v4, v174
  v_mfma_f32_16x16x32_bf16 v[168:171], v[222:225], v[152:155], v[168:171]
  v_cvt_pk_bf16_f32 v199, v174, v175
  s_waitcnt lgkmcnt(2)
  v_mfma_f32_16x16x32_bf16 v[160:163], v[226:229], v[124:127], v[160:163]
  ds_read_b128 v[222:225], v13 offset:51328
  v_exp_f32 v179, v179
  v_add_f32 v4, v4, v175
  v_mfma_f32_16x16x32_bf16 v[164:167], v[226:229], v[140:143], v[164:167]
  v_exp_f32 v180, v180
  v_mfma_f32_16x16x32_bf16 v[168:171], v[226:229], v[156:159], v[168:171]
  v_add_f32 v5, v5, v176
  s_waitcnt lgkmcnt(2)
  v_mfma_f32_16x16x32_bf16 v[184:187], v[214:217], v[112:115], 0
  ds_read_b128 v[226:229], v13 offset:51392
  v_cvt_pk_bf16_f32 v204, v176, v177
  v_mfma_f32_16x16x32_bf16 v[188:191], v[214:217], v[128:131], 0
  v_exp_f32 v181, v181
  v_add_f32 v5, v5, v177
  v_mfma_f32_16x16x32_bf16 v[192:195], v[214:217], v[144:147], 0
  ds_read_b64_tr_b16 v[230:231], v14 offset:33792
  v_exp_f32 v182, v182
  s_waitcnt lgkmcnt(3)
  v_mfma_f32_16x16x32_bf16 v[184:187], v[218:221], v[116:119], v[184:187]
  ds_read_b64_tr_b16 v[232:233], v14 offset:34304
  v_add_f32 v5, v5, v178
  v_mfma_f32_16x16x32_bf16 v[188:191], v[218:221], v[132:135], v[188:191]
  ds_read_b64_tr_b16 v[234:235], v14 offset:33824
  v_cvt_pk_bf16_f32 v205, v178, v179
  v_exp_f32 v183, v183
  v_mfma_f32_16x16x32_bf16 v[192:195], v[218:221], v[148:151], v[192:195]
  ds_read_b64_tr_b16 v[236:237], v14 offset:34336
  v_add_f32 v5, v5, v179
  s_waitcnt lgkmcnt(5)
  v_mfma_f32_16x16x32_bf16 v[184:187], v[222:225], v[120:123], v[184:187]
  ds_read_b64_tr_b16 v[238:239], v14 offset:33856
  v_add_f32 v6, v6, v180
  v_mfma_f32_16x16x32_bf16 v[188:191], v[222:225], v[136:139], v[188:191]
  ds_read_b64_tr_b16 v[240:241], v14 offset:34368
  v_cvt_pk_bf16_f32 v210, v180, v181
  v_add_f32 v6, v6, v181
  v_mfma_f32_16x16x32_bf16 v[192:195], v[222:225], v[152:155], v[192:195]
  ds_read_b64_tr_b16 v[242:243], v14 offset:33888
  v_add_f32 v6, v6, v182
  s_waitcnt lgkmcnt(7)
  v_mfma_f32_16x16x32_bf16 v[184:187], v[226:229], v[124:127], v[184:187]
  ds_read_b64_tr_b16 v[244:245], v14 offset:34400
  v_cvt_pk_bf16_f32 v211, v182, v183
  v_mfma_f32_16x16x32_bf16 v[188:191], v[226:229], v[140:143], v[188:191]
  v_add_f32 v6, v6, v183
  v_mfma_f32_16x16x32_bf16 v[192:195], v[226:229], v[156:159], v[192:195]
  s_waitcnt lgkmcnt(6)
  v_mfma_f32_16x16x32_bf16 v[16:19], v[230:233], v[196:199], v[16:19]
  v_exp_f32 v160, v160
  v_exp_f32 v161, v161
  v_mfma_f32_16x16x32_bf16 v[20:23], v[230:233], v[202:205], v[20:23]
  v_exp_f32 v162, v162
  v_mfma_f32_16x16x32_bf16 v[24:27], v[230:233], v[208:211], v[24:27]
  ds_read_b64_tr_b16 v[230:231], v14 offset:33920
  v_exp_f32 v163, v163
  s_waitcnt lgkmcnt(5)
  v_mfma_f32_16x16x32_bf16 v[28:31], v[234:237], v[196:199], v[28:31]
  ds_read_b64_tr_b16 v[232:233], v14 offset:34432
  v_exp_f32 v164, v164
  v_add_f32 v4, v4, v160
  v_mfma_f32_16x16x32_bf16 v[32:35], v[234:237], v[202:205], v[32:35]
  v_cvt_pk_bf16_f32 v200, v160, v161
  v_mfma_f32_16x16x32_bf16 v[36:39], v[234:237], v[208:211], v[36:39]
  ds_read_b64_tr_b16 v[234:235], v14 offset:33952
  v_exp_f32 v165, v165
  s_waitcnt lgkmcnt(5)
  v_mfma_f32_16x16x32_bf16 v[40:43], v[238:241], v[196:199], v[40:43]
  ds_read_b64_tr_b16 v[236:237], v14 offset:34464
  v_add_f32 v4, v4, v161
  v_exp_f32 v166, v166
  v_mfma_f32_16x16x32_bf16 v[44:47], v[238:241], v[202:205], v[44:47]
  v_add_f32 v4, v4, v162
  v_mfma_f32_16x16x32_bf16 v[48:51], v[238:241], v[208:211], v[48:51]
  ds_read_b64_tr_b16 v[238:239], v14 offset:33984
  v_cvt_pk_bf16_f32 v201, v162, v163
  s_waitcnt lgkmcnt(5)
  v_mfma_f32_16x16x32_bf16 v[52:55], v[242:245], v[196:199], v[52:55]
  ds_read_b64_tr_b16 v[240:241], v14 offset:34496
  v_exp_f32 v167, v167
  v_add_f32 v4, v4, v163
  v_mfma_f32_16x16x32_bf16 v[56:59], v[242:245], v[202:205], v[56:59]
  v_exp_f32 v168, v168
  v_mfma_f32_16x16x32_bf16 v[60:63], v[242:245], v[208:211], v[60:63]
  ds_read_b64_tr_b16 v[242:243], v14 offset:34016
  v_add_f32 v5, v5, v164
  s_waitcnt lgkmcnt(5)
  v_mfma_f32_16x16x32_bf16 v[64:67], v[230:233], v[196:199], v[64:67]
  ds_read_b64_tr_b16 v[244:245], v14 offset:34528
  v_cvt_pk_bf16_f32 v206, v164, v165
  v_mfma_f32_16x16x32_bf16 v[68:71], v[230:233], v[202:205], v[68:71]
  v_exp_f32 v169, v169
  v_add_f32 v5, v5, v165
  v_mfma_f32_16x16x32_bf16 v[72:75], v[230:233], v[208:211], v[72:75]
  v_exp_f32 v170, v170
  s_waitcnt lgkmcnt(4)
  v_mfma_f32_16x16x32_bf16 v[76:79], v[234:237], v[196:199], v[76:79]
  v_add_f32 v5, v5, v166
  v_mfma_f32_16x16x32_bf16 v[80:83], v[234:237], v[202:205], v[80:83]
  v_cvt_pk_bf16_f32 v207, v166, v167
  v_exp_f32 v171, v171
  s_waitcnt vmcnt(0) lgkmcnt(0)
  s_barrier
  s_add_u32 m0, s38, 33792
  s_nop 0
  buffer_load_dwordx4 v3, s[20:23], s32 offen nt lds
  s_add_u32 s32, s32, 8192
  v_mfma_f32_16x16x32_bf16 v[84:87], v[234:237], v[208:211], v[84:87]
  v_add_f32 v5, v5, v167
  s_add_u32 m0, s39, 33792
  s_nop 0
  buffer_load_dwordx4 v3, s[20:23], s33 offen nt lds
  s_add_u32 s33, s33, 8192
  ds_read_b128 v[214:217], v13 offset:0
  v_mfma_f32_16x16x32_bf16 v[88:91], v[238:241], v[196:199], v[88:91]
  v_add_f32 v6, v6, v168
  s_add_u32 m0, s40, 16896
  s_nop 0
  buffer_load_dwordx4 v3, s[24:27], s34 offen nt lds
  s_add_u32 s34, s34, 8192
  ds_read_b128 v[218:221], v13 offset:64
  v_mfma_f32_16x16x32_bf16 v[92:95], v[238:241], v[202:205], v[92:95]
  v_cvt_pk_bf16_f32 v212, v168, v169
  v_add_f32 v6, v6, v169
  s_add_u32 m0, s41, 16896
  s_nop 0
  buffer_load_dwordx4 v3, s[24:27], s35 offen nt lds
  s_add_u32 s35, s35, 8192
  ds_read_b128 v[222:225], v13 offset:128
  v_mfma_f32_16x16x32_bf16 v[96:99], v[238:241], v[208:211], v[96:99]
  v_add_f32 v6, v6, v170
  s_add_u32 m0, s38, 50688
  s_nop 0
  buffer_load_dwordx4 v3, s[20:23], s32 offen nt lds
  s_add_u32 s32, s32, 8192
  v_mfma_f32_16x16x32_bf16 v[100:103], v[242:245], v[196:199], v[100:103]
  v_cvt_pk_bf16_f32 v213, v170, v171
  s_add_u32 m0, s39, 50688
  s_nop 0
  buffer_load_dwordx4 v3, s[20:23], s33 offen nt lds
  s_add_u32 s33, s33, 8192
  v_mfma_f32_16x16x32_bf16 v[104:107], v[242:245], v[202:205], v[104:107]
  v_add_f32 v6, v6, v171
  s_add_u32 m0, s40, 33792
  s_nop 0
  buffer_load_dwordx4 v3, s[24:27], s34 offen nt lds
  s_add_u32 s34, s34, 8192
  v_mfma_f32_16x16x32_bf16 v[108:111], v[242:245], v[208:211], v[108:111]
  s_add_u32 m0, s41, 33792
  s_nop 0
  buffer_load_dwordx4 v3, s[24:27], s35 offen nt lds
  s_add_u32 s35, s35, 8192
  s_cmp_eq_u32 s42, 1
  s_cbranch_scc1 concat_heads__mha_block_cached__gqa_block_cached__near_ridge_kernel_h_tail
  s_waitcnt lgkmcnt(2)
  v_mfma_f32_16x16x32_bf16 v[160:163], v[214:217], v[112:115], 0
  ds_read_b128 v[226:229], v13 offset:192
  v_exp_f32 v184, v184
  v_exp_f32 v185, v185
  v_mfma_f32_16x16x32_bf16 v[164:167], v[214:217], v[128:131], 0
  v_exp_f32 v186, v186
  v_mfma_f32_16x16x32_bf16 v[168:171], v[214:217], v[144:147], 0
  v_exp_f32 v187, v187
  s_waitcnt lgkmcnt(2)
  v_mfma_f32_16x16x32_bf16 v[160:163], v[218:221], v[116:119], v[160:163]
  ds_read_b128 v[214:217], v13 offset:512
  v_exp_f32 v188, v188
  v_add_f32 v4, v4, v184
  v_mfma_f32_16x16x32_bf16 v[164:167], v[218:221], v[132:135], v[164:167]
  v_cvt_pk_bf16_f32 v198, v184, v185
  v_mfma_f32_16x16x32_bf16 v[168:171], v[218:221], v[148:151], v[168:171]
  v_exp_f32 v189, v189
  s_waitcnt lgkmcnt(2)
  v_mfma_f32_16x16x32_bf16 v[160:163], v[222:225], v[120:123], v[160:163]
  ds_read_b128 v[218:221], v13 offset:576
  v_add_f32 v4, v4, v185
  v_exp_f32 v190, v190
  v_mfma_f32_16x16x32_bf16 v[164:167], v[222:225], v[136:139], v[164:167]
  v_add_f32 v4, v4, v186
  v_mfma_f32_16x16x32_bf16 v[168:171], v[222:225], v[152:155], v[168:171]
  v_cvt_pk_bf16_f32 v199, v186, v187
  s_waitcnt lgkmcnt(2)
  v_mfma_f32_16x16x32_bf16 v[160:163], v[226:229], v[124:127], v[160:163]
  ds_read_b128 v[222:225], v13 offset:640
  v_exp_f32 v191, v191
  v_add_f32 v4, v4, v187
  v_mfma_f32_16x16x32_bf16 v[164:167], v[226:229], v[140:143], v[164:167]
  v_exp_f32 v192, v192
  v_mfma_f32_16x16x32_bf16 v[168:171], v[226:229], v[156:159], v[168:171]
  v_add_f32 v5, v5, v188
  s_waitcnt lgkmcnt(2)
  v_mfma_f32_16x16x32_bf16 v[172:175], v[214:217], v[112:115], 0
  ds_read_b128 v[226:229], v13 offset:704
  v_cvt_pk_bf16_f32 v204, v188, v189
  v_mfma_f32_16x16x32_bf16 v[176:179], v[214:217], v[128:131], 0
  v_exp_f32 v193, v193
  v_add_f32 v5, v5, v189
  v_mfma_f32_16x16x32_bf16 v[180:183], v[214:217], v[144:147], 0
  ds_read_b64_tr_b16 v[232:233], v14 offset:50688
  v_exp_f32 v194, v194
  s_waitcnt lgkmcnt(3)
  v_mfma_f32_16x16x32_bf16 v[172:175], v[218:221], v[116:119], v[172:175]
  ds_read_b64_tr_b16 v[230:231], v14 offset:51200
  v_add_f32 v5, v5, v190
  v_mfma_f32_16x16x32_bf16 v[176:179], v[218:221], v[132:135], v[176:179]
  ds_read_b64_tr_b16 v[236:237], v14 offset:50720
  v_cvt_pk_bf16_f32 v205, v190, v191
  v_exp_f32 v195, v195
  v_mfma_f32_16x16x32_bf16 v[180:183], v[218:221], v[148:151], v[180:183]
  ds_read_b64_tr_b16 v[234:235], v14 offset:51232
  v_add_f32 v5, v5, v191
  s_waitcnt lgkmcnt(5)
  v_mfma_f32_16x16x32_bf16 v[172:175], v[222:225], v[120:123], v[172:175]
  ds_read_b64_tr_b16 v[240:241], v14 offset:50752
  v_add_f32 v6, v6, v192
  v_mfma_f32_16x16x32_bf16 v[176:179], v[222:225], v[136:139], v[176:179]
  ds_read_b64_tr_b16 v[238:239], v14 offset:51264
  v_cvt_pk_bf16_f32 v210, v192, v193
  v_add_f32 v6, v6, v193
  v_mfma_f32_16x16x32_bf16 v[180:183], v[222:225], v[152:155], v[180:183]
  ds_read_b64_tr_b16 v[244:245], v14 offset:50784
  v_add_f32 v6, v6, v194
  s_waitcnt lgkmcnt(7)
  v_mfma_f32_16x16x32_bf16 v[172:175], v[226:229], v[124:127], v[172:175]
  ds_read_b64_tr_b16 v[242:243], v14 offset:51296
  v_cvt_pk_bf16_f32 v211, v194, v195
  v_mfma_f32_16x16x32_bf16 v[176:179], v[226:229], v[140:143], v[176:179]
  v_add_f32 v6, v6, v195
  v_mfma_f32_16x16x32_bf16 v[180:183], v[226:229], v[156:159], v[180:183]
  s_waitcnt lgkmcnt(6)
  v_mfma_f32_16x16x32_bf16 v[16:19], v[230:233], v[198:201], v[16:19]
  v_exp_f32 v160, v160
  v_exp_f32 v161, v161
  v_mfma_f32_16x16x32_bf16 v[20:23], v[230:233], v[204:207], v[20:23]
  v_exp_f32 v162, v162
  v_mfma_f32_16x16x32_bf16 v[24:27], v[230:233], v[210:213], v[24:27]
  ds_read_b64_tr_b16 v[232:233], v14 offset:50816
  v_exp_f32 v163, v163
  s_waitcnt lgkmcnt(5)
  v_mfma_f32_16x16x32_bf16 v[28:31], v[234:237], v[198:201], v[28:31]
  ds_read_b64_tr_b16 v[230:231], v14 offset:51328
  v_exp_f32 v164, v164
  v_add_f32 v4, v4, v160
  v_mfma_f32_16x16x32_bf16 v[32:35], v[234:237], v[204:207], v[32:35]
  v_cvt_pk_bf16_f32 v196, v160, v161
  v_mfma_f32_16x16x32_bf16 v[36:39], v[234:237], v[210:213], v[36:39]
  ds_read_b64_tr_b16 v[236:237], v14 offset:50848
  v_exp_f32 v165, v165
  s_waitcnt lgkmcnt(5)
  v_mfma_f32_16x16x32_bf16 v[40:43], v[238:241], v[198:201], v[40:43]
  ds_read_b64_tr_b16 v[234:235], v14 offset:51360
  v_add_f32 v4, v4, v161
  v_exp_f32 v166, v166
  v_mfma_f32_16x16x32_bf16 v[44:47], v[238:241], v[204:207], v[44:47]
  v_add_f32 v4, v4, v162
  v_mfma_f32_16x16x32_bf16 v[48:51], v[238:241], v[210:213], v[48:51]
  ds_read_b64_tr_b16 v[240:241], v14 offset:50880
  v_cvt_pk_bf16_f32 v197, v162, v163
  s_waitcnt lgkmcnt(5)
  v_mfma_f32_16x16x32_bf16 v[52:55], v[242:245], v[198:201], v[52:55]
  ds_read_b64_tr_b16 v[238:239], v14 offset:51392
  v_exp_f32 v167, v167
  v_add_f32 v4, v4, v163
  v_mfma_f32_16x16x32_bf16 v[56:59], v[242:245], v[204:207], v[56:59]
  v_exp_f32 v168, v168
  v_mfma_f32_16x16x32_bf16 v[60:63], v[242:245], v[210:213], v[60:63]
  ds_read_b64_tr_b16 v[244:245], v14 offset:50912
  v_add_f32 v5, v5, v164
  s_waitcnt lgkmcnt(5)
  v_mfma_f32_16x16x32_bf16 v[64:67], v[230:233], v[198:201], v[64:67]
  ds_read_b64_tr_b16 v[242:243], v14 offset:51424
  v_cvt_pk_bf16_f32 v202, v164, v165
  v_mfma_f32_16x16x32_bf16 v[68:71], v[230:233], v[204:207], v[68:71]
  v_exp_f32 v169, v169
  v_add_f32 v5, v5, v165
  v_mfma_f32_16x16x32_bf16 v[72:75], v[230:233], v[210:213], v[72:75]
  v_exp_f32 v170, v170
  s_waitcnt lgkmcnt(4)
  v_mfma_f32_16x16x32_bf16 v[76:79], v[234:237], v[198:201], v[76:79]
  v_add_f32 v5, v5, v166
  v_mfma_f32_16x16x32_bf16 v[80:83], v[234:237], v[204:207], v[80:83]
  v_cvt_pk_bf16_f32 v203, v166, v167
  v_exp_f32 v171, v171
  v_mfma_f32_16x16x32_bf16 v[84:87], v[234:237], v[210:213], v[84:87]
  v_add_f32 v5, v5, v167
  ds_read_b128 v[214:217], v13 offset:16896
  s_waitcnt lgkmcnt(3)
  v_mfma_f32_16x16x32_bf16 v[88:91], v[238:241], v[198:201], v[88:91]
  v_add_f32 v6, v6, v168
  ds_read_b128 v[218:221], v13 offset:16960
  v_mfma_f32_16x16x32_bf16 v[92:95], v[238:241], v[204:207], v[92:95]
  v_cvt_pk_bf16_f32 v208, v168, v169
  v_add_f32 v6, v6, v169
  ds_read_b128 v[222:225], v13 offset:17024
  v_mfma_f32_16x16x32_bf16 v[96:99], v[238:241], v[210:213], v[96:99]
  v_add_f32 v6, v6, v170
  s_waitcnt lgkmcnt(3)
  v_mfma_f32_16x16x32_bf16 v[100:103], v[242:245], v[198:201], v[100:103]
  v_cvt_pk_bf16_f32 v209, v170, v171
  v_mfma_f32_16x16x32_bf16 v[104:107], v[242:245], v[204:207], v[104:107]
  v_add_f32 v6, v6, v171
  v_mfma_f32_16x16x32_bf16 v[108:111], v[242:245], v[210:213], v[108:111]
  s_sub_u32 s42, s42, 1
  s_branch concat_heads__mha_block_cached__gqa_block_cached__near_ridge_kernel_h_aloop
concat_heads__mha_block_cached__gqa_block_cached__near_ridge_kernel_h_tail:
  ds_read_b64_tr_b16 v[232:233], v14 offset:50688
  ds_read_b64_tr_b16 v[230:231], v14 offset:51200
  ds_read_b64_tr_b16 v[236:237], v14 offset:50720
  ds_read_b64_tr_b16 v[234:235], v14 offset:51232
  ds_read_b64_tr_b16 v[240:241], v14 offset:50752
  ds_read_b64_tr_b16 v[238:239], v14 offset:51264
  ds_read_b64_tr_b16 v[244:245], v14 offset:50784
  ds_read_b64_tr_b16 v[242:243], v14 offset:51296
  v_exp_f32 v184, v184
  v_exp_f32 v185, v185
  v_exp_f32 v186, v186
  v_exp_f32 v187, v187
  v_exp_f32 v188, v188
  v_add_f32 v4, v4, v184
  v_cvt_pk_bf16_f32 v198, v184, v185
  v_exp_f32 v189, v189
  v_add_f32 v4, v4, v185
  v_exp_f32 v190, v190
  v_add_f32 v4, v4, v186
  v_cvt_pk_bf16_f32 v199, v186, v187
  v_exp_f32 v191, v191
  v_add_f32 v4, v4, v187
  v_exp_f32 v192, v192
  v_add_f32 v5, v5, v188
  v_cvt_pk_bf16_f32 v204, v188, v189
  v_exp_f32 v193, v193
  v_add_f32 v5, v5, v189
  v_exp_f32 v194, v194
  v_add_f32 v5, v5, v190
  v_cvt_pk_bf16_f32 v205, v190, v191
  v_exp_f32 v195, v195
  v_add_f32 v5, v5, v191
  v_add_f32 v6, v6, v192
  v_cvt_pk_bf16_f32 v210, v192, v193
  v_add_f32 v6, v6, v193
  v_add_f32 v6, v6, v194
  v_cvt_pk_bf16_f32 v211, v194, v195
  v_add_f32 v6, v6, v195
  s_waitcnt lgkmcnt(6)
  v_mfma_f32_16x16x32_bf16 v[16:19], v[230:233], v[198:201], v[16:19]
  v_mfma_f32_16x16x32_bf16 v[20:23], v[230:233], v[204:207], v[20:23]
  v_mfma_f32_16x16x32_bf16 v[24:27], v[230:233], v[210:213], v[24:27]
  ds_read_b64_tr_b16 v[232:233], v14 offset:50816
  s_waitcnt lgkmcnt(5)
  v_mfma_f32_16x16x32_bf16 v[28:31], v[234:237], v[198:201], v[28:31]
  ds_read_b64_tr_b16 v[230:231], v14 offset:51328
  v_mfma_f32_16x16x32_bf16 v[32:35], v[234:237], v[204:207], v[32:35]
  v_mfma_f32_16x16x32_bf16 v[36:39], v[234:237], v[210:213], v[36:39]
  ds_read_b64_tr_b16 v[236:237], v14 offset:50848
  s_waitcnt lgkmcnt(5)
  v_mfma_f32_16x16x32_bf16 v[40:43], v[238:241], v[198:201], v[40:43]
  ds_read_b64_tr_b16 v[234:235], v14 offset:51360
  v_mfma_f32_16x16x32_bf16 v[44:47], v[238:241], v[204:207], v[44:47]
  v_mfma_f32_16x16x32_bf16 v[48:51], v[238:241], v[210:213], v[48:51]
  ds_read_b64_tr_b16 v[240:241], v14 offset:50880
  s_waitcnt lgkmcnt(5)
  v_mfma_f32_16x16x32_bf16 v[52:55], v[242:245], v[198:201], v[52:55]
  ds_read_b64_tr_b16 v[238:239], v14 offset:51392
  v_mfma_f32_16x16x32_bf16 v[56:59], v[242:245], v[204:207], v[56:59]
  v_mfma_f32_16x16x32_bf16 v[60:63], v[242:245], v[210:213], v[60:63]
  ds_read_b64_tr_b16 v[244:245], v14 offset:50912
  s_waitcnt lgkmcnt(5)
  v_mfma_f32_16x16x32_bf16 v[64:67], v[230:233], v[198:201], v[64:67]
  ds_read_b64_tr_b16 v[242:243], v14 offset:51424
  v_mfma_f32_16x16x32_bf16 v[68:71], v[230:233], v[204:207], v[68:71]
  v_mfma_f32_16x16x32_bf16 v[72:75], v[230:233], v[210:213], v[72:75]
  s_waitcnt lgkmcnt(4)
  v_mfma_f32_16x16x32_bf16 v[76:79], v[234:237], v[198:201], v[76:79]
  v_mfma_f32_16x16x32_bf16 v[80:83], v[234:237], v[204:207], v[80:83]
  v_mfma_f32_16x16x32_bf16 v[84:87], v[234:237], v[210:213], v[84:87]
  s_waitcnt lgkmcnt(2)
  v_mfma_f32_16x16x32_bf16 v[88:91], v[238:241], v[198:201], v[88:91]
  v_mfma_f32_16x16x32_bf16 v[92:95], v[238:241], v[204:207], v[92:95]
  v_mfma_f32_16x16x32_bf16 v[96:99], v[238:241], v[210:213], v[96:99]
  s_waitcnt lgkmcnt(0)
  v_mfma_f32_16x16x32_bf16 v[100:103], v[242:245], v[198:201], v[100:103]
  v_mfma_f32_16x16x32_bf16 v[104:107], v[242:245], v[204:207], v[104:107]
  v_mfma_f32_16x16x32_bf16 v[108:111], v[242:245], v[210:213], v[108:111]
  v_mov_b32 v254, 0
  s_cmp_eq_u32 s4, 0
  s_cbranch_scc0 concat_heads__mha_block_cached__gqa_block_cached__near_ridge_kernel_h_nn
  buffer_load_dword v255, v254, s[64:67], 0 offen sc1
concat_heads__mha_block_cached__gqa_block_cached__near_ridge_kernel_h_nn:
  s_mov_b32 s78, 0
concat_heads__mha_block_cached__gqa_block_cached__near_ridge_kernel_h_e0:
  v_mov_b32 v7, v4
  s_nop 1
  v_permlane32_swap_b32 v7, v4
  v_add_f32 v4, v4, v7
  v_mov_b32 v8, v5
  s_nop 1
  v_permlane32_swap_b32 v8, v5
  v_add_f32 v5, v5, v8
  v_mov_b32 v9, v6
  s_nop 1
  v_permlane32_swap_b32 v9, v6
  v_add_f32 v6, v6, v9
  v_mov_b32 v7, v4
  s_nop 1
  v_permlane16_swap_b32 v7, v4
  v_add_f32 v4, v4, v7
  v_mov_b32 v8, v5
  s_nop 1
  v_permlane16_swap_b32 v8, v5
  v_add_f32 v5, v5, v8
  v_mov_b32 v9, v6
  s_nop 1
  v_permlane16_swap_b32 v9, v6
  v_add_f32 v6, v6, v9
  s_mov_b64 s[48:49], 0
  v_mov_b32 v11, 0x2b800000
  v_mov_b32 v12, 0x53800000
  v_cmp_nle_f32 vcc, v11, v4
  s_nop 1
  s_or_b64 s[48:49], s[48:49], vcc
  v_cmp_nge_f32 vcc, v12, v4
  s_nop 1
  s_or_b64 s[48:49], s[48:49], vcc
  v_cmp_nle_f32 vcc, v11, v5
  s_nop 1
  s_or_b64 s[48:49], s[48:49], vcc
  v_cmp_nge_f32 vcc, v12, v5
  s_nop 1
  s_or_b64 s[48:49], s[48:49], vcc
  v_cmp_nle_f32 vcc, v11, v6
  s_nop 1
  s_or_b64 s[48:49], s[48:49], vcc
  v_cmp_nge_f32 vcc, v12, v6
  s_nop 1
  s_or_b64 s[48:49], s[48:49], vcc
  s_cmp_lg_u64 s[48:49], 0
  s_cselect_b32 s48, 1, 0
  s_andn2_b32 s48, s48, s78
  s_lshl_b32 s49, s4, 2
  s_add_u32 s49, s49, 81856
  v_mov_b32 v11, s48
  v_mov_b32 v12, s49
  ds_write_b32 v12, v11 offset:0
  v_rcp_f32 v7, v4
  v_rcp_f32 v8, v5
  v_rcp_f32 v9, v6
  s_mul_i32 s46, s6, 12
  s_mul_i32 s47, s4, 3
  s_add_u32 s46, s46, s47
  s_add_u32 s46, s46, 0
  s_lshr_b32 s47, s46, 3
  s_lshl_b32 s47, s47, 20
  s_and_b32 s46, s46, 7
  s_lshl_b32 s46, s46, 10
  s_add_u32 s43, s46, s47
  s_mul_i32 s46, s6, 12
  s_mul_i32 s47, s4, 3
  s_add_u32 s46, s46, s47
  s_add_u32 s46, s46, 1
  s_lshr_b32 s47, s46, 3
  s_lshl_b32 s47, s47, 20
  s_and_b32 s46, s46, 7
  s_lshl_b32 s46, s46, 10
  s_add_u32 s44, s46, s47
  s_mul_i32 s46, s6, 12
  s_mul_i32 s47, s4, 3
  s_add_u32 s46, s46, s47
  s_add_u32 s46, s46, 2
  s_lshr_b32 s47, s46, 3
  s_lshl_b32 s47, s47, 20
  s_and_b32 s46, s46, 7
  s_lshl_b32 s46, s46, 10
  s_add_u32 s45, s46, s47
  v_mul_f32 v16, v16, v7
  v_mul_f32 v28, v28, v7
  v_mul_f32 v17, v17, v7
  v_mul_f32 v29, v29, v7
  v_mul_f32 v18, v18, v7
  v_mul_f32 v30, v30, v7
  v_mul_f32 v19, v19, v7
  v_mul_f32 v31, v31, v7
  v_cvt_pk_bf16_f32 v16, v16, v17
  v_cvt_pk_bf16_f32 v17, v18, v19
  v_cvt_pk_bf16_f32 v18, v28, v29
  v_cvt_pk_bf16_f32 v19, v30, v31
  buffer_store_dwordx4 v[16:19], v3, s[28:31], s43 offen sc1
  s_add_u32 s43, s43, 8192
  v_mul_f32 v40, v40, v7
  v_mul_f32 v52, v52, v7
  v_mul_f32 v41, v41, v7
  v_mul_f32 v53, v53, v7
  v_mul_f32 v42, v42, v7
  v_mul_f32 v54, v54, v7
  v_mul_f32 v43, v43, v7
  v_mul_f32 v55, v55, v7
  v_cvt_pk_bf16_f32 v40, v40, v41
  v_cvt_pk_bf16_f32 v41, v42, v43
  v_cvt_pk_bf16_f32 v42, v52, v53
  v_cvt_pk_bf16_f32 v43, v54, v55
  buffer_store_dwordx4 v[40:43], v3, s[28:31], s43 offen sc1
  s_add_u32 s43, s43, 8192
  v_mul_f32 v64, v64, v7
  v_mul_f32 v76, v76, v7
  v_mul_f32 v65, v65, v7
  v_mul_f32 v77, v77, v7
  v_mul_f32 v66, v66, v7
  v_mul_f32 v78, v78, v7
  v_mul_f32 v67, v67, v7
  v_mul_f32 v79, v79, v7
  v_cvt_pk_bf16_f32 v64, v64, v65
  v_cvt_pk_bf16_f32 v65, v66, v67
  v_cvt_pk_bf16_f32 v66, v76, v77
  v_cvt_pk_bf16_f32 v67, v78, v79
  buffer_store_dwordx4 v[64:67], v3, s[28:31], s43 offen sc1
  s_add_u32 s43, s43, 8192
  v_mul_f32 v88, v88, v7
  v_mul_f32 v100, v100, v7
  v_mul_f32 v89, v89, v7
  v_mul_f32 v101, v101, v7
  v_mul_f32 v90, v90, v7
  v_mul_f32 v102, v102, v7
  v_mul_f32 v91, v91, v7
  v_mul_f32 v103, v103, v7
  v_cvt_pk_bf16_f32 v88, v88, v89
  v_cvt_pk_bf16_f32 v89, v90, v91
  v_cvt_pk_bf16_f32 v90, v100, v101
  v_cvt_pk_bf16_f32 v91, v102, v103
  buffer_store_dwordx4 v[88:91], v3, s[28:31], s43 offen sc1
  v_mul_f32 v20, v20, v8
  v_mul_f32 v32, v32, v8
  v_mul_f32 v21, v21, v8
  v_mul_f32 v33, v33, v8
  v_mul_f32 v22, v22, v8
  v_mul_f32 v34, v34, v8
  v_mul_f32 v23, v23, v8
  v_mul_f32 v35, v35, v8
  v_cvt_pk_bf16_f32 v20, v20, v21
  v_cvt_pk_bf16_f32 v21, v22, v23
  v_cvt_pk_bf16_f32 v22, v32, v33
  v_cvt_pk_bf16_f32 v23, v34, v35
  buffer_store_dwordx4 v[20:23], v3, s[28:31], s44 offen sc1
  s_add_u32 s44, s44, 8192
  v_mul_f32 v44, v44, v8
  v_mul_f32 v56, v56, v8
  v_mul_f32 v45, v45, v8
  v_mul_f32 v57, v57, v8
  v_mul_f32 v46, v46, v8
  v_mul_f32 v58, v58, v8
  v_mul_f32 v47, v47, v8
  v_mul_f32 v59, v59, v8
  v_cvt_pk_bf16_f32 v44, v44, v45
  v_cvt_pk_bf16_f32 v45, v46, v47
  v_cvt_pk_bf16_f32 v46, v56, v57
  v_cvt_pk_bf16_f32 v47, v58, v59
  buffer_store_dwordx4 v[44:47], v3, s[28:31], s44 offen sc1
  s_add_u32 s44, s44, 8192
  v_mul_f32 v68, v68, v8
  v_mul_f32 v80, v80, v8
  v_mul_f32 v69, v69, v8
  v_mul_f32 v81, v81, v8
  v_mul_f32 v70, v70, v8
  v_mul_f32 v82, v82, v8
  v_mul_f32 v71, v71, v8
  v_mul_f32 v83, v83, v8
  v_cvt_pk_bf16_f32 v68, v68, v69
  v_cvt_pk_bf16_f32 v69, v70, v71
  v_cvt_pk_bf16_f32 v70, v80, v81
  v_cvt_pk_bf16_f32 v71, v82, v83
  buffer_store_dwordx4 v[68:71], v3, s[28:31], s44 offen sc1
  s_add_u32 s44, s44, 8192
  v_mul_f32 v92, v92, v8
  v_mul_f32 v104, v104, v8
  v_mul_f32 v93, v93, v8
  v_mul_f32 v105, v105, v8
  v_mul_f32 v94, v94, v8
  v_mul_f32 v106, v106, v8
  v_mul_f32 v95, v95, v8
  v_mul_f32 v107, v107, v8
  v_cvt_pk_bf16_f32 v92, v92, v93
  v_cvt_pk_bf16_f32 v93, v94, v95
  v_cvt_pk_bf16_f32 v94, v104, v105
  v_cvt_pk_bf16_f32 v95, v106, v107
  buffer_store_dwordx4 v[92:95], v3, s[28:31], s44 offen sc1
  v_mul_f32 v24, v24, v9
  v_mul_f32 v36, v36, v9
  v_mul_f32 v25, v25, v9
  v_mul_f32 v37, v37, v9
  v_mul_f32 v26, v26, v9
  v_mul_f32 v38, v38, v9
  v_mul_f32 v27, v27, v9
  v_mul_f32 v39, v39, v9
  v_cvt_pk_bf16_f32 v24, v24, v25
  v_cvt_pk_bf16_f32 v25, v26, v27
  v_cvt_pk_bf16_f32 v26, v36, v37
  v_cvt_pk_bf16_f32 v27, v38, v39
  buffer_store_dwordx4 v[24:27], v3, s[28:31], s45 offen sc1
  s_add_u32 s45, s45, 8192
  v_mul_f32 v48, v48, v9
  v_mul_f32 v60, v60, v9
  v_mul_f32 v49, v49, v9
  v_mul_f32 v61, v61, v9
  v_mul_f32 v50, v50, v9
  v_mul_f32 v62, v62, v9
  v_mul_f32 v51, v51, v9
  v_mul_f32 v63, v63, v9
  v_cvt_pk_bf16_f32 v48, v48, v49
  v_cvt_pk_bf16_f32 v49, v50, v51
  v_cvt_pk_bf16_f32 v50, v60, v61
  v_cvt_pk_bf16_f32 v51, v62, v63
  buffer_store_dwordx4 v[48:51], v3, s[28:31], s45 offen sc1
  s_add_u32 s45, s45, 8192
  v_mul_f32 v72, v72, v9
  v_mul_f32 v84, v84, v9
  v_mul_f32 v73, v73, v9
  v_mul_f32 v85, v85, v9
  v_mul_f32 v74, v74, v9
  v_mul_f32 v86, v86, v9
  v_mul_f32 v75, v75, v9
  v_mul_f32 v87, v87, v9
  v_cvt_pk_bf16_f32 v72, v72, v73
  v_cvt_pk_bf16_f32 v73, v74, v75
  v_cvt_pk_bf16_f32 v74, v84, v85
  v_cvt_pk_bf16_f32 v75, v86, v87
  buffer_store_dwordx4 v[72:75], v3, s[28:31], s45 offen sc1
  s_add_u32 s45, s45, 8192
  v_mul_f32 v96, v96, v9
  v_mul_f32 v108, v108, v9
  v_mul_f32 v97, v97, v9
  v_mul_f32 v109, v109, v9
  v_mul_f32 v98, v98, v9
  v_mul_f32 v110, v110, v9
  v_mul_f32 v99, v99, v9
  v_mul_f32 v111, v111, v9
  v_cvt_pk_bf16_f32 v96, v96, v97
  v_cvt_pk_bf16_f32 v97, v98, v99
  v_cvt_pk_bf16_f32 v98, v108, v109
  v_cvt_pk_bf16_f32 v99, v110, v111
  buffer_store_dwordx4 v[96:99], v3, s[28:31], s45 offen sc1
  s_waitcnt vmcnt(0) lgkmcnt(0)
  s_barrier
  v_mov_b32 v12, 81856
  ds_read_b128 v[160:163], v12 offset:0
  s_waitcnt lgkmcnt(0)
  v_or_b32 v160, v160, v161
  v_or_b32 v162, v162, v163
  v_or_b32 v160, v160, v162
  s_nop 0
  v_readfirstlane_b32 s45, v160
  s_nop 3
  s_cmp_lg_u32 s45, 0
  s_cbranch_scc1 concat_heads__mha_block_cached__gqa_block_cached__near_ridge_kernel_h_fb
  s_cmp_eq_u32 s4, 0
  s_cbranch_scc0 concat_heads__mha_block_cached__gqa_block_cached__near_ridge_kernel_h_nopub
  v_readfirstlane_b32 s73, v255
  s_nop 3
  s_cmp_lg_u32 s73, 0
  s_cbranch_scc1 concat_heads__mha_block_cached__gqa_block_cached__near_ridge_kernel_h_pn_done
  s_mov_b32 s43, 0
  s_mov_b32 s48, 200000
concat_heads__mha_block_cached__gqa_block_cached__near_ridge_kernel_h_pn:
  v_mov_b32 v254, 0
  buffer_load_dword v255, v254, s[64:67], s43 offen sc1
  s_waitcnt vmcnt(0)
  v_readfirstlane_b32 s49, v255
  s_sub_u32 s48, s48, 1
  s_cbranch_scc1 concat_heads__mha_block_cached__gqa_block_cached__near_ridge_kernel_h_pn_ok
  s_nop 2
  s_cmp_ge_u32 s49, 1
  s_cbranch_scc1 concat_heads__mha_block_cached__gqa_block_cached__near_ridge_kernel_h_pn_ok
  s_sleep 8
  s_branch concat_heads__mha_block_cached__gqa_block_cached__near_ridge_kernel_h_pn
concat_heads__mha_block_cached__gqa_block_cached__near_ridge_kernel_h_pn_ok:
  s_mov_b32 s73, s49
concat_heads__mha_block_cached__gqa_block_cached__near_ridge_kernel_h_pn_done:
  s_lshl_b32 s43, s5, 3
  s_add_u32 s43, s43, s6
  s_mul_i32 s43, s43, 384
  s_lshl_b32 s44, s7, 2
  s_add_u32 s43, s43, s44
  s_add_u32 s43, s43, 33554432
  s_add_u32 s68, s60, s43
  s_addc_u32 s69, s61, 0
  s_and_b32 s69, s69, 0xffff
  s_mov_b32 s70, 260
  s_mov_b32 s71, 0x20000
  v_lshlrev_b32 v16, 7, v0
  v_mov_b32 v17, s73
  s_mov_b64 exec, 7
  buffer_store_dword v17, v16, s[68:71], 0 offen sc1
concat_heads__mha_block_cached__gqa_block_cached__near_ridge_kernel_h_nopub:
  s_endpgm
  s_nop 15
concat_heads__mha_block_cached__gqa_block_cached__near_ridge_kernel_h_fb:
  v_mov_b32 v246, 0xff800000
  v_mov_b32 v247, 0xff800000
  v_mov_b32 v248, 0xff800000
  s_lshl_b32 s32, s4, 10
  s_add_u32 s33, s32, 4096
  s_mov_b32 s34, s32
  s_mov_b32 s35, s33
  s_mov_b32 s42, 16
concat_heads__mha_block_cached__gqa_block_cached__near_ridge_kernel_h_fb1:
  s_barrier
  s_mov_b32 m0, s38
  s_nop 0
  buffer_load_dwordx4 v3, s[20:23], s32 offen lds
  s_add_u32 s32, s32, 8192
  s_mov_b32 m0, s39
  s_nop 0
  buffer_load_dwordx4 v3, s[20:23], s33 offen lds
  s_add_u32 s33, s33, 8192
  s_waitcnt vmcnt(0)
  s_barrier
  ds_read_b128 v[214:217], v13 offset:0
  ds_read_b128 v[218:221], v13 offset:64
  ds_read_b128 v[222:225], v13 offset:128
  ds_read_b128 v[226:229], v13 offset:192
  s_waitcnt lgkmcnt(3)
  v_mfma_f32_16x16x32_bf16 v[160:163], v[214:217], v[112:115], 0
  v_mfma_f32_16x16x32_bf16 v[164:167], v[214:217], v[128:131], 0
  v_mfma_f32_16x16x32_bf16 v[168:171], v[214:217], v[144:147], 0
  s_waitcnt lgkmcnt(2)
  v_mfma_f32_16x16x32_bf16 v[160:163], v[218:221], v[116:119], v[160:163]
  v_mfma_f32_16x16x32_bf16 v[164:167], v[218:221], v[132:135], v[164:167]
  v_mfma_f32_16x16x32_bf16 v[168:171], v[218:221], v[148:151], v[168:171]
  s_waitcnt lgkmcnt(1)
  v_mfma_f32_16x16x32_bf16 v[160:163], v[222:225], v[120:123], v[160:163]
  v_mfma_f32_16x16x32_bf16 v[164:167], v[222:225], v[136:139], v[164:167]
  v_mfma_f32_16x16x32_bf16 v[168:171], v[222:225], v[152:155], v[168:171]
  s_waitcnt lgkmcnt(0)
  v_mfma_f32_16x16x32_bf16 v[160:163], v[226:229], v[124:127], v[160:163]
  v_mfma_f32_16x16x32_bf16 v[164:167], v[226:229], v[140:143], v[164:167]
  v_mfma_f32_16x16x32_bf16 v[168:171], v[226:229], v[156:159], v[168:171]
  ds_read_b128 v[214:217], v13 offset:512
  ds_read_b128 v[218:221], v13 offset:576
  ds_read_b128 v[222:225], v13 offset:640
  ds_read_b128 v[226:229], v13 offset:704
  s_waitcnt lgkmcnt(3)
  v_mfma_f32_16x16x32_bf16 v[172:175], v[214:217], v[112:115], 0
  v_mfma_f32_16x16x32_bf16 v[176:179], v[214:217], v[128:131], 0
  v_mfma_f32_16x16x32_bf16 v[180:183], v[214:217], v[144:147], 0
  s_waitcnt lgkmcnt(2)
  v_mfma_f32_16x16x32_bf16 v[172:175], v[218:221], v[116:119], v[172:175]
  v_mfma_f32_16x16x32_bf16 v[176:179], v[218:221], v[132:135], v[176:179]
  v_mfma_f32_16x16x32_bf16 v[180:183], v[218:221], v[148:151], v[180:183]
  s_waitcnt lgkmcnt(1)
  v_mfma_f32_16x16x32_bf16 v[172:175], v[222:225], v[120:123], v[172:175]
  v_mfma_f32_16x16x32_bf16 v[176:179], v[222:225], v[136:139], v[176:179]
  v_mfma_f32_16x16x32_bf16 v[180:183], v[222:225], v[152:155], v[180:183]
  s_waitcnt lgkmcnt(0)
  v_mfma_f32_16x16x32_bf16 v[172:175], v[226:229], v[124:127], v[172:175]
  v_mfma_f32_16x16x32_bf16 v[176:179], v[226:229], v[140:143], v[176:179]
  v_mfma_f32_16x16x32_bf16 v[180:183], v[226:229], v[156:159], v[180:183]
  v_max3_f32 v246, v246, v160, v161
  v_max3_f32 v246, v246, v162, v163
  s_nop 3
  v_max3_f32 v246, v246, v172, v173
  v_max3_f32 v246, v246, v174, v175
  v_max3_f32 v247, v247, v164, v165
  v_max3_f32 v247, v247, v166, v167
  v_max3_f32 v247, v247, v176, v177
  v_max3_f32 v247, v247, v178, v179
  v_max3_f32 v248, v248, v168, v169
  v_max3_f32 v248, v248, v170, v171
  v_max3_f32 v248, v248, v180, v181
  v_max3_f32 v248, v248, v182, v183
  s_waitcnt lgkmcnt(0)
  s_sub_u32 s42, s42, 1
  s_cmp_lg_u32 s42, 0
  s_cbranch_scc1 concat_heads__mha_block_cached__gqa_block_cached__near_ridge_kernel_h_fb1
  v_mov_b32 v249, v246
  s_nop 1
  v_permlane32_swap_b32 v249, v246
  v_max_f32 v246, v246, v249
  v_mov_b32 v249, v246
  s_nop 1
  v_permlane16_swap_b32 v249, v246
  v_max_f32 v246, v246, v249
  v_sub_f32 v184, 0, v246
  v_sub_f32 v185, 0, v246
  v_sub_f32 v186, 0, v246
  v_sub_f32 v187, 0, v246
  v_mov_b32 v249, v247
  s_nop 1
  v_permlane32_swap_b32 v249, v247
  v_max_f32 v247, v247, v249
  v_mov_b32 v249, v247
  s_nop 1
  v_permlane16_swap_b32 v249, v247
  v_max_f32 v247, v247, v249
  v_sub_f32 v188, 0, v247
  v_sub_f32 v189, 0, v247
  v_sub_f32 v190, 0, v247
  v_sub_f32 v191, 0, v247
  v_mov_b32 v249, v248
  s_nop 1
  v_permlane32_swap_b32 v249, v248
  v_max_f32 v248, v248, v249
  v_mov_b32 v249, v248
  s_nop 1
  v_permlane16_swap_b32 v249, v248
  v_max_f32 v248, v248, v249
  v_sub_f32 v192, 0, v248
  v_sub_f32 v193, 0, v248
  v_sub_f32 v194, 0, v248
  v_sub_f32 v195, 0, v248
  v_mov_b32 v16, 0
  v_mov_b32 v17, 0
  v_mov_b32 v18, 0
  v_mov_b32 v19, 0
  v_mov_b32 v20, 0
  v_mov_b32 v21, 0
  v_mov_b32 v22, 0
  v_mov_b32 v23, 0
  v_mov_b32 v24, 0
  v_mov_b32 v25, 0
  v_mov_b32 v26, 0
  v_mov_b32 v27, 0
  v_mov_b32 v28, 0
  v_mov_b32 v29, 0
  v_mov_b32 v30, 0
  v_mov_b32 v31, 0
  v_mov_b32 v32, 0
  v_mov_b32 v33, 0
  v_mov_b32 v34, 0
  v_mov_b32 v35, 0
  v_mov_b32 v36, 0
  v_mov_b32 v37, 0
  v_mov_b32 v38, 0
  v_mov_b32 v39, 0
  v_mov_b32 v40, 0
  v_mov_b32 v41, 0
  v_mov_b32 v42, 0
  v_mov_b32 v43, 0
  v_mov_b32 v44, 0
  v_mov_b32 v45, 0
  v_mov_b32 v46, 0
  v_mov_b32 v47, 0
  v_mov_b32 v48, 0
  v_mov_b32 v49, 0
  v_mov_b32 v50, 0
  v_mov_b32 v51, 0
  v_mov_b32 v52, 0
  v_mov_b32 v53, 0
  v_mov_b32 v54, 0
  v_mov_b32 v55, 0
  v_mov_b32 v56, 0
  v_mov_b32 v57, 0
  v_mov_b32 v58, 0
  v_mov_b32 v59, 0
  v_mov_b32 v60, 0
  v_mov_b32 v61, 0
  v_mov_b32 v62, 0
  v_mov_b32 v63, 0
  v_mov_b32 v64, 0
  v_mov_b32 v65, 0
  v_mov_b32 v66, 0
  v_mov_b32 v67, 0
  v_mov_b32 v68, 0
  v_mov_b32 v69, 0
  v_mov_b32 v70, 0
  v_mov_b32 v71, 0
  v_mov_b32 v72, 0
  v_mov_b32 v73, 0
  v_mov_b32 v74, 0
  v_mov_b32 v75, 0
  v_mov_b32 v76, 0
  v_mov_b32 v77, 0
  v_mov_b32 v78, 0
  v_mov_b32 v79, 0
  v_mov_b32 v80, 0
  v_mov_b32 v81, 0
  v_mov_b32 v82, 0
  v_mov_b32 v83, 0
  v_mov_b32 v84, 0
  v_mov_b32 v85, 0
  v_mov_b32 v86, 0
  v_mov_b32 v87, 0
  v_mov_b32 v88, 0
  v_mov_b32 v89, 0
  v_mov_b32 v90, 0
  v_mov_b32 v91, 0
  v_mov_b32 v92, 0
  v_mov_b32 v93, 0
  v_mov_b32 v94, 0
  v_mov_b32 v95, 0
  v_mov_b32 v96, 0
  v_mov_b32 v97, 0
  v_mov_b32 v98, 0
  v_mov_b32 v99, 0
  v_mov_b32 v100, 0
  v_mov_b32 v101, 0
  v_mov_b32 v102, 0
  v_mov_b32 v103, 0
  v_mov_b32 v104, 0
  v_mov_b32 v105, 0
  v_mov_b32 v106, 0
  v_mov_b32 v107, 0
  v_mov_b32 v108, 0
  v_mov_b32 v109, 0
  v_mov_b32 v110, 0
  v_mov_b32 v111, 0
  v_mov_b32 v4, 0
  v_mov_b32 v5, 0
  v_mov_b32 v6, 0
  s_lshl_b32 s32, s4, 10
  s_add_u32 s33, s32, 4096
  s_mov_b32 s34, s32
  s_mov_b32 s35, s33
  s_mov_b32 s42, 16
concat_heads__mha_block_cached__gqa_block_cached__near_ridge_kernel_h_fb2:
  s_barrier
  s_mov_b32 m0, s38
  s_nop 0
  buffer_load_dwordx4 v3, s[20:23], s32 offen lds
  s_add_u32 s32, s32, 8192
  s_mov_b32 m0, s39
  s_nop 0
  buffer_load_dwordx4 v3, s[20:23], s33 offen lds
  s_add_u32 s33, s33, 8192
  s_mov_b32 m0, s40
  s_nop 0
  buffer_load_dwordx4 v3, s[24:27], s34 offen lds
  s_add_u32 s34, s34, 8192
  s_mov_b32 m0, s41
  s_nop 0
  buffer_load_dwordx4 v3, s[24:27], s35 offen lds
  s_add_u32 s35, s35, 8192
  s_waitcnt vmcnt(0)
  s_barrier
  ds_read_b128 v[214:217], v13 offset:0
  ds_read_b128 v[218:221], v13 offset:64
  ds_read_b128 v[222:225], v13 offset:128
  ds_read_b128 v[226:229], v13 offset:192
  s_waitcnt lgkmcnt(3)
  v_mfma_f32_16x16x32_bf16 v[160:163], v[214:217], v[112:115], v[184:187]
  v_mfma_f32_16x16x32_bf16 v[164:167], v[214:217], v[128:131], v[188:191]
  v_mfma_f32_16x16x32_bf16 v[168:171], v[214:217], v[144:147], v[192:195]
  s_waitcnt lgkmcnt(2)
  v_mfma_f32_16x16x32_bf16 v[160:163], v[218:221], v[116:119], v[160:163]
  v_mfma_f32_16x16x32_bf16 v[164:167], v[218:221], v[132:135], v[164:167]
  v_mfma_f32_16x16x32_bf16 v[168:171], v[218:221], v[148:151], v[168:171]
  s_waitcnt lgkmcnt(1)
  v_mfma_f32_16x16x32_bf16 v[160:163], v[222:225], v[120:123], v[160:163]
  v_mfma_f32_16x16x32_bf16 v[164:167], v[222:225], v[136:139], v[164:167]
  v_mfma_f32_16x16x32_bf16 v[168:171], v[222:225], v[152:155], v[168:171]
  s_waitcnt lgkmcnt(0)
  v_mfma_f32_16x16x32_bf16 v[160:163], v[226:229], v[124:127], v[160:163]
  v_mfma_f32_16x16x32_bf16 v[164:167], v[226:229], v[140:143], v[164:167]
  v_mfma_f32_16x16x32_bf16 v[168:171], v[226:229], v[156:159], v[168:171]
  ds_read_b128 v[214:217], v13 offset:512
  ds_read_b128 v[218:221], v13 offset:576
  ds_read_b128 v[222:225], v13 offset:640
  ds_read_b128 v[226:229], v13 offset:704
  s_waitcnt lgkmcnt(3)
  v_mfma_f32_16x16x32_bf16 v[172:175], v[214:217], v[112:115], v[184:187]
  v_mfma_f32_16x16x32_bf16 v[176:179], v[214:217], v[128:131], v[188:191]
  v_mfma_f32_16x16x32_bf16 v[180:183], v[214:217], v[144:147], v[192:195]
  s_waitcnt lgkmcnt(2)
  v_mfma_f32_16x16x32_bf16 v[172:175], v[218:221], v[116:119], v[172:175]
  v_mfma_f32_16x16x32_bf16 v[176:179], v[218:221], v[132:135], v[176:179]
  v_mfma_f32_16x16x32_bf16 v[180:183], v[218:221], v[148:151], v[180:183]
  s_waitcnt lgkmcnt(1)
  v_mfma_f32_16x16x32_bf16 v[172:175], v[222:225], v[120:123], v[172:175]
  v_mfma_f32_16x16x32_bf16 v[176:179], v[222:225], v[136:139], v[176:179]
  v_mfma_f32_16x16x32_bf16 v[180:183], v[222:225], v[152:155], v[180:183]
  s_waitcnt lgkmcnt(0)
  v_mfma_f32_16x16x32_bf16 v[172:175], v[226:229], v[124:127], v[172:175]
  v_mfma_f32_16x16x32_bf16 v[176:179], v[226:229], v[140:143], v[176:179]
  v_mfma_f32_16x16x32_bf16 v[180:183], v[226:229], v[156:159], v[180:183]
  v_exp_f32 v160, v160
  v_exp_f32 v161, v161
  v_exp_f32 v162, v162
  v_exp_f32 v163, v163
  v_add_f32 v4, v4, v160
  v_add_f32 v4, v4, v161
  v_add_f32 v4, v4, v162
  v_add_f32 v4, v4, v163
  v_cvt_pk_bf16_f32 v196, v160, v161
  v_cvt_pk_bf16_f32 v197, v162, v163
  v_exp_f32 v164, v164
  v_exp_f32 v165, v165
  v_exp_f32 v166, v166
  v_exp_f32 v167, v167
  v_add_f32 v5, v5, v164
  v_add_f32 v5, v5, v165
  v_add_f32 v5, v5, v166
  v_add_f32 v5, v5, v167
  v_cvt_pk_bf16_f32 v202, v164, v165
  v_cvt_pk_bf16_f32 v203, v166, v167
  v_exp_f32 v168, v168
  v_exp_f32 v169, v169
  v_exp_f32 v170, v170
  v_exp_f32 v171, v171
  v_add_f32 v6, v6, v168
  v_add_f32 v6, v6, v169
  v_add_f32 v6, v6, v170
  v_add_f32 v6, v6, v171
  v_cvt_pk_bf16_f32 v208, v168, v169
  v_cvt_pk_bf16_f32 v209, v170, v171
  v_exp_f32 v172, v172
  v_exp_f32 v173, v173
  v_exp_f32 v174, v174
  v_exp_f32 v175, v175
  v_add_f32 v4, v4, v172
  v_add_f32 v4, v4, v173
  v_add_f32 v4, v4, v174
  v_add_f32 v4, v4, v175
  v_cvt_pk_bf16_f32 v198, v172, v173
  v_cvt_pk_bf16_f32 v199, v174, v175
  v_exp_f32 v176, v176
  v_exp_f32 v177, v177
  v_exp_f32 v178, v178
  v_exp_f32 v179, v179
  v_add_f32 v5, v5, v176
  v_add_f32 v5, v5, v177
  v_add_f32 v5, v5, v178
  v_add_f32 v5, v5, v179
  v_cvt_pk_bf16_f32 v204, v176, v177
  v_cvt_pk_bf16_f32 v205, v178, v179
  v_exp_f32 v180, v180
  v_exp_f32 v181, v181
  v_exp_f32 v182, v182
  v_exp_f32 v183, v183
  v_add_f32 v6, v6, v180
  v_add_f32 v6, v6, v181
  v_add_f32 v6, v6, v182
  v_add_f32 v6, v6, v183
  v_cvt_pk_bf16_f32 v210, v180, v181
  v_cvt_pk_bf16_f32 v211, v182, v183
  ds_read_b64_tr_b16 v[230:231], v14 offset:0
  ds_read_b64_tr_b16 v[232:233], v14 offset:512
  ds_read_b64_tr_b16 v[234:235], v14 offset:32
  ds_read_b64_tr_b16 v[236:237], v14 offset:544
  ds_read_b64_tr_b16 v[238:239], v14 offset:64
  ds_read_b64_tr_b16 v[240:241], v14 offset:576
  ds_read_b64_tr_b16 v[242:243], v14 offset:96
  ds_read_b64_tr_b16 v[244:245], v14 offset:608
  s_waitcnt lgkmcnt(6)
  v_mfma_f32_16x16x32_bf16 v[16:19], v[230:233], v[196:199], v[16:19]
  v_mfma_f32_16x16x32_bf16 v[20:23], v[230:233], v[202:205], v[20:23]
  v_mfma_f32_16x16x32_bf16 v[24:27], v[230:233], v[208:211], v[24:27]
  s_waitcnt lgkmcnt(4)
  v_mfma_f32_16x16x32_bf16 v[28:31], v[234:237], v[196:199], v[28:31]
  v_mfma_f32_16x16x32_bf16 v[32:35], v[234:237], v[202:205], v[32:35]
  v_mfma_f32_16x16x32_bf16 v[36:39], v[234:237], v[208:211], v[36:39]
  s_waitcnt lgkmcnt(2)
  v_mfma_f32_16x16x32_bf16 v[40:43], v[238:241], v[196:199], v[40:43]
  v_mfma_f32_16x16x32_bf16 v[44:47], v[238:241], v[202:205], v[44:47]
  v_mfma_f32_16x16x32_bf16 v[48:51], v[238:241], v[208:211], v[48:51]
  s_waitcnt lgkmcnt(0)
  v_mfma_f32_16x16x32_bf16 v[52:55], v[242:245], v[196:199], v[52:55]
  v_mfma_f32_16x16x32_bf16 v[56:59], v[242:245], v[202:205], v[56:59]
  v_mfma_f32_16x16x32_bf16 v[60:63], v[242:245], v[208:211], v[60:63]
  ds_read_b64_tr_b16 v[230:231], v14 offset:128
  ds_read_b64_tr_b16 v[232:233], v14 offset:640
  ds_read_b64_tr_b16 v[234:235], v14 offset:160
  ds_read_b64_tr_b16 v[236:237], v14 offset:672
  ds_read_b64_tr_b16 v[238:239], v14 offset:192
  ds_read_b64_tr_b16 v[240:241], v14 offset:704
  ds_read_b64_tr_b16 v[242:243], v14 offset:224
  ds_read_b64_tr_b16 v[244:245], v14 offset:736
  s_waitcnt lgkmcnt(6)
  v_mfma_f32_16x16x32_bf16 v[64:67], v[230:233], v[196:199], v[64:67]
  v_mfma_f32_16x16x32_bf16 v[68:71], v[230:233], v[202:205], v[68:71]
  v_mfma_f32_16x16x32_bf16 v[72:75], v[230:233], v[208:211], v[72:75]
  s_waitcnt lgkmcnt(4)
  v_mfma_f32_16x16x32_bf16 v[76:79], v[234:237], v[196:199], v[76:79]
  v_mfma_f32_16x16x32_bf16 v[80:83], v[234:237], v[202:205], v[80:83]
  v_mfma_f32_16x16x32_bf16 v[84:87], v[234:237], v[208:211], v[84:87]
  s_waitcnt lgkmcnt(2)
  v_mfma_f32_16x16x32_bf16 v[88:91], v[238:241], v[196:199], v[88:91]
  v_mfma_f32_16x16x32_bf16 v[92:95], v[238:241], v[202:205], v[92:95]
  v_mfma_f32_16x16x32_bf16 v[96:99], v[238:241], v[208:211], v[96:99]
  s_waitcnt lgkmcnt(0)
  v_mfma_f32_16x16x32_bf16 v[100:103], v[242:245], v[196:199], v[100:103]
  v_mfma_f32_16x16x32_bf16 v[104:107], v[242:245], v[202:205], v[104:107]
  v_mfma_f32_16x16x32_bf16 v[108:111], v[242:245], v[208:211], v[108:111]
  s_waitcnt lgkmcnt(0)
  s_sub_u32 s42, s42, 1
  s_cmp_lg_u32 s42, 0
  s_cbranch_scc1 concat_heads__mha_block_cached__gqa_block_cached__near_ridge_kernel_h_fb2
  s_nop 15
  s_mov_b32 s78, 1
  s_branch concat_heads__mha_block_cached__gqa_block_cached__near_ridge_kernel_h_e0
concat_heads__mha_block_cached__gqa_block_cached__near_ridge_kernel_oproj:
  s_sub_u32 s72, s2, 512
  s_and_b32 s3, s72, 7
  s_lshr_b32 s5, s3, 2
  s_lshr_b32 s8, s72, 3
  s_mul_i32 s44, s8, 6554
  s_lshr_b32 s44, s44, 16
  s_and_b32 s45, s3, 3
  s_mul_i32 s45, s45, 3
  s_add_u32 s6, s45, s44
  s_mul_i32 s44, s44, 10
  s_sub_u32 s7, s8, s44
  s_mul_i32 s3, s5, 40
  s_add_u32 s3, s3, 32
  s_load_dwordx2 s[52:53], s[0:1], s3
  s_load_dwordx4 s[56:59], s[0:1], 80
  s_load_dwordx2 s[60:61], s[0:1], 96
  v_lshrrev_b32 v7, 6, v0
  v_and_b32 v0, 63, v0
  s_nop 0
  v_readfirstlane_b32 s4, v7
  v_lshrrev_b32 v7, 4, v0
  v_and_b32 v8, 15, v0
  v_bfe_u32 v9, v0, 2, 2
  v_and_b32 v10, 3, v0
  v_lshlrev_b32 v1, 4, v0
  v_add_u32 v2, 4096, v1
  v_lshrrev_b32 v16, 3, v0
  v_mul_u32_u24 v16, 5120, v16
  v_and_b32 v17, 7, v0
  v_lshl_add_u32 v3, v17, 4, v16
  s_mul_i32 s37, s4, 12672
  v_mul_u32_u24 v16, 1056, v9
  v_lshl_add_u32 v16, v7, 7, v16
  v_lshl_add_u32 v16, v10, 3, v16
  v_add_u32 v4, s37, v16
  s_lshl_b32 s41, s4, 13
  s_mul_i32 s40, s4, 40960
  s_waitcnt lgkmcnt(0)
  s_mul_i32 s43, s5, 12
  s_add_u32 s43, s43, s6
  s_lshl_b32 s43, s43, 20
  s_add_u32 s12, s60, s43
  s_addc_u32 s13, s61, 0
  s_and_b32 s13, s13, 0xffff
  s_mov_b32 s14, 1048576
  s_mov_b32 s15, 0x20000
  s_lshl_b32 s43, s7, 7
  s_add_u32 s16, s52, s43
  s_addc_u32 s17, s53, 0
  s_and_b32 s17, s17, 0xffff
  s_mov_b32 s18, 5241728
  s_mov_b32 s19, 0x20000
  s_mul_i32 s43, s6, 327680
  s_mul_i32 s44, s5, 1280
  s_add_u32 s43, s43, s44
  s_lshl_b32 s44, s7, 7
  s_add_u32 s43, s43, s44
  s_add_u32 s20, s56, s43
  s_addc_u32 s21, s57, 0
  s_and_b32 s21, s21, 0xffff
  s_mov_b32 s22, 325248
  s_mov_b32 s23, 0x20000
  s_mov_b32 s64, s58
  s_and_b32 s65, s59, 0xffff
  s_mov_b32 s66, 256
  s_mov_b32 s67, 0x20000
  s_mov_b32 s43, 0
  s_cmp_eq_u32 s4, 0
  s_cbranch_scc0 concat_heads__mha_block_cached__gqa_block_cached__near_ridge_kernel_o_nw
  s_mov_b32 s48, 200000
concat_heads__mha_block_cached__gqa_block_cached__near_ridge_kernel_o_pn:
  v_mov_b32 v5, 0
  buffer_load_dword v6, v5, s[64:67], s43 offen sc1
  s_waitcnt vmcnt(0)
  v_readfirstlane_b32 s49, v6
  s_sub_u32 s48, s48, 1
  s_cbranch_scc1 concat_heads__mha_block_cached__gqa_block_cached__near_ridge_kernel_o_pn_ok
  s_nop 2
  s_cmp_ge_u32 s49, 1
  s_cbranch_scc1 concat_heads__mha_block_cached__gqa_block_cached__near_ridge_kernel_o_pn_ok
  s_sleep 8
  s_branch concat_heads__mha_block_cached__gqa_block_cached__near_ridge_kernel_o_pn
concat_heads__mha_block_cached__gqa_block_cached__near_ridge_kernel_o_pn_ok:
  v_mov_b32 v6, s49
  v_mov_b32 v5, 81856
  ds_write_b32 v5, v6 offset:0
  s_waitcnt lgkmcnt(0)
concat_heads__mha_block_cached__gqa_block_cached__near_ridge_kernel_o_nw:
  s_barrier
  v_mov_b32 v5, 81856
  ds_read_b32 v6, v5 offset:0
  s_waitcnt lgkmcnt(0)
  v_readfirstlane_b32 s73, v6
  s_nop 3
  s_mul_i32 s43, s6, 43691
  s_lshr_b32 s43, s43, 16
  s_lshl_b32 s44, s6, 7
  s_add_u32 s44, s44, 127
  s_mul_i32 s44, s44, 21846
  s_lshr_b32 s44, s44, 22
  s_sub_u32 s44, s44, s43
  s_mul_i32 s44, s44, 384
  s_lshl_b32 s45, s5, 3
  s_add_u32 s43, s43, s45
  s_mul_i32 s43, s43, 384
  s_mul_i32 s45, s7, 21846
  s_lshr_b32 s45, s45, 16
  s_mul_i32 s45, s45, 3
  s_sub_u32 s45, s7, s45
  s_lshl_b32 s45, s45, 7
  s_add_u32 s43, s43, s45
  s_add_u32 s43, s43, 33554432
  s_add_u32 s24, s60, s43
  s_addc_u32 s25, s61, 0
  s_and_b32 s25, s25, 0xffff
  s_mov_b32 s26, 512
  s_mov_b32 s27, 0x20000
  s_cmp_eq_u32 s5, 0
  s_cselect_b32 s10, 3072, 0
  v_and_b32 v5, 31, v0
  v_lshlrev_b32 v5, 2, v5
  v_lshrrev_b32 v16, 5, v0
  v_mul_lo_u32 v16, s44, v16
  v_add_u32 v5, v5, v16
  s_mov_b32 s38, 0
  s_mov_b32 s39, 0
  s_and_b32 s9, s8, 0
  v_mov_b32 v16, 0
  v_mov_b32 v17, 0
  v_mov_b32 v18, 0
  v_mov_b32 v19, 0
  v_mov_b32 v20, 0
  v_mov_b32 v21, 0
  v_mov_b32 v22, 0
  v_mov_b32 v23, 0
  v_mov_b32 v24, 0
  v_mov_b32 v25, 0
  v_mov_b32 v26, 0
  v_mov_b32 v27, 0
  v_mov_b32 v28, 0
  v_mov_b32 v29, 0
  v_mov_b32 v30, 0
  v_mov_b32 v31, 0
  v_mov_b32 v32, 0
  v_mov_b32 v33, 0
  v_mov_b32 v34, 0
  v_mov_b32 v35, 0
  v_mov_b32 v36, 0
  v_mov_b32 v37, 0
  v_mov_b32 v38, 0
  v_mov_b32 v39, 0
  v_mov_b32 v40, 0
  v_mov_b32 v41, 0
  v_mov_b32 v42, 0
  v_mov_b32 v43, 0
  v_mov_b32 v44, 0
  v_mov_b32 v45, 0
  v_mov_b32 v46, 0
  v_mov_b32 v47, 0
  v_mov_b32 v48, 0
  v_mov_b32 v49, 0
  v_mov_b32 v50, 0
  v_mov_b32 v51, 0
  v_mov_b32 v52, 0
  v_mov_b32 v53, 0
  v_mov_b32 v54, 0
  v_mov_b32 v55, 0
  v_mov_b32 v56, 0
  v_mov_b32 v57, 0
  v_mov_b32 v58, 0
  v_mov_b32 v59, 0
  v_mov_b32 v60, 0
  v_mov_b32 v61, 0
  v_mov_b32 v62, 0
  v_mov_b32 v63, 0
  v_mov_b32 v64, 0
  v_mov_b32 v65, 0
  v_mov_b32 v66, 0
  v_mov_b32 v67, 0
  v_mov_b32 v68, 0
  v_mov_b32 v69, 0
  v_mov_b32 v70, 0
  v_mov_b32 v71, 0
  v_mov_b32 v72, 0
  v_mov_b32 v73, 0
  v_mov_b32 v74, 0
  v_mov_b32 v75, 0
  v_mov_b32 v76, 0
  v_mov_b32 v77, 0
  v_mov_b32 v78, 0
  v_mov_b32 v79, 0
  v_mov_b32 v80, 0
  v_mov_b32 v81, 0
  v_mov_b32 v82, 0
  v_mov_b32 v83, 0
  v_mov_b32 v84, 0
  v_mov_b32 v85, 0
  v_mov_b32 v86, 0
  v_mov_b32 v87, 0
  v_mov_b32 v88, 0
  v_mov_b32 v89, 0
  v_mov_b32 v90, 0
  v_mov_b32 v91, 0
  v_mov_b32 v92, 0
  v_mov_b32 v93, 0
  v_mov_b32 v94, 0
  v_mov_b32 v95, 0
  v_mov_b32 v96, 0
  v_mov_b32 v97, 0
  v_mov_b32 v98, 0
  v_mov_b32 v99, 0
  v_mov_b32 v100, 0
  v_mov_b32 v101, 0
  v_mov_b32 v102, 0
  v_mov_b32 v103, 0
  v_mov_b32 v104, 0
  v_mov_b32 v105, 0
  v_mov_b32 v106, 0
  v_mov_b32 v107, 0
  v_mov_b32 v108, 0
  v_mov_b32 v109, 0
  v_mov_b32 v110, 0
  v_mov_b32 v111, 0
  v_mov_b32 v112, 0
  v_mov_b32 v113, 0
  v_mov_b32 v114, 0
  v_mov_b32 v115, 0
  v_mov_b32 v116, 0
  v_mov_b32 v117, 0
  v_mov_b32 v118, 0
  v_mov_b32 v119, 0
  v_mov_b32 v120, 0
  v_mov_b32 v121, 0
  v_mov_b32 v122, 0
  v_mov_b32 v123, 0
  v_mov_b32 v124, 0
  v_mov_b32 v125, 0
  v_mov_b32 v126, 0
  v_mov_b32 v127, 0
  v_mov_b32 v128, 0
  v_mov_b32 v129, 0
  v_mov_b32 v130, 0
  v_mov_b32 v131, 0
  v_mov_b32 v132, 0
  v_mov_b32 v133, 0
  v_mov_b32 v134, 0
  v_mov_b32 v135, 0
  v_mov_b32 v136, 0
  v_mov_b32 v137, 0
  v_mov_b32 v138, 0
  v_mov_b32 v139, 0
  v_mov_b32 v140, 0
  v_mov_b32 v141, 0
  v_mov_b32 v142, 0
  v_mov_b32 v143, 0
  s_cmp_lg_u32 s38, 0
  s_cbranch_scc1 concat_heads__mha_block_cached__gqa_block_cached__near_ridge_kernel_o_s1_have
  s_mov_b32 s43, 32
  s_cmp_eq_u32 s39, -1
  s_cbranch_scc1 concat_heads__mha_block_cached__gqa_block_cached__near_ridge_kernel_o_s1_addr
  s_mov_b32 s48, 200000
concat_heads__mha_block_cached__gqa_block_cached__near_ridge_kernel_o_s1_poll:
  buffer_load_dword v6, v5, s[24:27], 0 offen sc1
  s_waitcnt vmcnt(0)
  v_cmp_eq_u32 vcc, s73, v6
  s_sub_u32 s48, s48, 1
  s_cselect_b32 s44, -1, 0
  s_nop 2
  s_and_b32 s43, vcc_lo, vcc_hi
  s_or_b32 s44, s44, s43
  s_andn2_b32 s38, s44, s39
  s_cbranch_scc1 concat_heads__mha_block_cached__gqa_block_cached__near_ridge_kernel_o_s1_have
  s_sleep 64
  s_branch concat_heads__mha_block_cached__gqa_block_cached__near_ridge_kernel_o_s1_poll
concat_heads__mha_block_cached__gqa_block_cached__near_ridge_kernel_o_s1_have:
  s_mov_b32 s46, s38
  s_mov_b32 s47, s38
  s_lshr_b64 s[46:47], s[46:47], s9
  s_ff1_i32_b32 s43, s46
  s_add_u32 s43, s43, s9
  s_and_b32 s43, s43, 31
  s_lshl_b32 s44, 1, s43
  s_or_b32 s39, s39, s44
  s_andn2_b32 s38, s38, s44
concat_heads__mha_block_cached__gqa_block_cached__near_ridge_kernel_o_s1_addr:
  s_lshl_b32 s44, s43, 15
  s_add_u32 s32, s41, s44
  s_mul_i32 s44, s43, 163840
  s_add_u32 s33, s40, s44
  s_add_u32 s34, s33, 1280
  s_add_u32 s35, s33, 2560
  s_add_u32 s36, s33, 3840
  buffer_load_dwordx4 v[144:147], v1, s[12:15], s32 offen sc1
  buffer_load_dwordx4 v[148:151], v1, s[12:15], s32 offen offset:1024 sc1
  buffer_load_dwordx4 v[152:155], v1, s[12:15], s32 offen offset:2048 sc1
  buffer_load_dwordx4 v[156:159], v1, s[12:15], s32 offen offset:3072 sc1
  buffer_load_dwordx4 v[160:163], v2, s[12:15], s32 offen sc1
  buffer_load_dwordx4 v[164:167], v2, s[12:15], s32 offen offset:1024 sc1
  buffer_load_dwordx4 v[168:171], v2, s[12:15], s32 offen offset:2048 sc1
  buffer_load_dwordx4 v[172:175], v2, s[12:15], s32 offen offset:3072 sc1
  s_mov_b32 m0, s37
  s_nop 0
  buffer_load_dwordx4 v3, s[16:19], s33 offen lds
  s_add_u32 m0, s37, 1056
  s_nop 0
  buffer_load_dwordx4 v3, s[16:19], s34 offen lds
  s_add_u32 m0, s37, 2112
  s_nop 0
  buffer_load_dwordx4 v3, s[16:19], s35 offen lds
  s_add_u32 m0, s37, 3168
  s_nop 0
  buffer_load_dwordx4 v3, s[16:19], s36 offen lds
  s_cmp_lg_u32 s38, 0
  s_cbranch_scc1 concat_heads__mha_block_cached__gqa_block_cached__near_ridge_kernel_o_s2_have
  s_mov_b32 s43, 32
  s_cmp_eq_u32 s39, -1
  s_cbranch_scc1 concat_heads__mha_block_cached__gqa_block_cached__near_ridge_kernel_o_s2_addr
  s_mov_b32 s48, 200000
concat_heads__mha_block_cached__gqa_block_cached__near_ridge_kernel_o_s2_poll:
  buffer_load_dword v6, v5, s[24:27], 0 offen sc1
  s_waitcnt vmcnt(0)
  v_cmp_eq_u32 vcc, s73, v6
  s_sub_u32 s48, s48, 1
  s_cselect_b32 s44, -1, 0
  s_nop 2
  s_and_b32 s43, vcc_lo, vcc_hi
  s_or_b32 s44, s44, s43
  s_andn2_b32 s38, s44, s39
  s_cbranch_scc1 concat_heads__mha_block_cached__gqa_block_cached__near_ridge_kernel_o_s2_have
  s_sleep 64
  s_branch concat_heads__mha_block_cached__gqa_block_cached__near_ridge_kernel_o_s2_poll
concat_heads__mha_block_cached__gqa_block_cached__near_ridge_kernel_o_s2_have:
  s_mov_b32 s46, s38
  s_mov_b32 s47, s38
  s_lshr_b64 s[46:47], s[46:47], s9
  s_ff1_i32_b32 s43, s46
  s_add_u32 s43, s43, s9
  s_and_b32 s43, s43, 31
  s_lshl_b32 s44, 1, s43
  s_or_b32 s39, s39, s44
  s_andn2_b32 s38, s38, s44
concat_heads__mha_block_cached__gqa_block_cached__near_ridge_kernel_o_s2_addr:
  s_lshl_b32 s44, s43, 15
  s_add_u32 s32, s41, s44
  s_mul_i32 s44, s43, 163840
  s_add_u32 s33, s40, s44
  s_add_u32 s34, s33, 1280
  s_add_u32 s35, s33, 2560
  s_add_u32 s36, s33, 3840
  buffer_load_dwordx4 v[176:179], v1, s[12:15], s32 offen sc1
  buffer_load_dwordx4 v[180:183], v1, s[12:15], s32 offen offset:1024 sc1
  buffer_load_dwordx4 v[184:187], v1, s[12:15], s32 offen offset:2048 sc1
  buffer_load_dwordx4 v[188:191], v1, s[12:15], s32 offen offset:3072 sc1
  buffer_load_dwordx4 v[192:195], v2, s[12:15], s32 offen sc1
  buffer_load_dwordx4 v[196:199], v2, s[12:15], s32 offen offset:1024 sc1
  buffer_load_dwordx4 v[200:203], v2, s[12:15], s32 offen offset:2048 sc1
  buffer_load_dwordx4 v[204:207], v2, s[12:15], s32 offen offset:3072 sc1
  s_add_u32 m0, s37, 4224
  s_nop 0
  buffer_load_dwordx4 v3, s[16:19], s33 offen lds
  s_add_u32 m0, s37, 5280
  s_nop 0
  buffer_load_dwordx4 v3, s[16:19], s34 offen lds
  s_add_u32 m0, s37, 6336
  s_nop 0
  buffer_load_dwordx4 v3, s[16:19], s35 offen lds
  s_add_u32 m0, s37, 7392
  s_nop 0
  buffer_load_dwordx4 v3, s[16:19], s36 offen lds
  s_waitcnt vmcnt(12)
  ds_read_b64_tr_b16 v[240:241], v4 offset:0
  ds_read_b64_tr_b16 v[242:243], v4 offset:512
  ds_read_b64_tr_b16 v[244:245], v4 offset:32
  ds_read_b64_tr_b16 v[246:247], v4 offset:544
  ds_read_b64_tr_b16 v[248:249], v4 offset:64
  ds_read_b64_tr_b16 v[250:251], v4 offset:576
  ds_read_b64_tr_b16 v[252:253], v4 offset:96
  ds_read_b64_tr_b16 v[254:255], v4 offset:608
  s_mov_b32 s42, 10
concat_heads__mha_block_cached__gqa_block_cached__near_ridge_kernel_o_loop:
  s_waitcnt lgkmcnt(6)
  v_mfma_f32_16x16x32_bf16 v[16:19], v[240:243], v[144:147], v[16:19]
  s_cmp_lg_u32 s38, 0
  s_cbranch_scc1 concat_heads__mha_block_cached__gqa_block_cached__near_ridge_kernel_o_s3_have
  s_mov_b32 s43, 32
  s_cmp_eq_u32 s39, -1
  s_cbranch_scc1 concat_heads__mha_block_cached__gqa_block_cached__near_ridge_kernel_o_s3_addr
  s_mov_b32 s48, 200000
concat_heads__mha_block_cached__gqa_block_cached__near_ridge_kernel_o_s3_poll:
  buffer_load_dword v6, v5, s[24:27], 0 offen sc1
  s_waitcnt vmcnt(0)
  v_cmp_eq_u32 vcc, s73, v6
  s_sub_u32 s48, s48, 1
  s_cselect_b32 s44, -1, 0
  s_nop 2
  s_and_b32 s43, vcc_lo, vcc_hi
  s_or_b32 s44, s44, s43
  s_andn2_b32 s38, s44, s39
  s_cbranch_scc1 concat_heads__mha_block_cached__gqa_block_cached__near_ridge_kernel_o_s3_have
  s_sleep 64
  s_branch concat_heads__mha_block_cached__gqa_block_cached__near_ridge_kernel_o_s3_poll
concat_heads__mha_block_cached__gqa_block_cached__near_ridge_kernel_o_s3_have:
  s_mov_b32 s46, s38
  s_mov_b32 s47, s38
  s_lshr_b64 s[46:47], s[46:47], s9
  s_ff1_i32_b32 s43, s46
  s_add_u32 s43, s43, s9
  s_and_b32 s43, s43, 31
  s_lshl_b32 s44, 1, s43
  s_or_b32 s39, s39, s44
  s_andn2_b32 s38, s38, s44
concat_heads__mha_block_cached__gqa_block_cached__near_ridge_kernel_o_s3_addr:
  s_lshl_b32 s44, s43, 15
  s_add_u32 s32, s41, s44
  s_mul_i32 s44, s43, 163840
  s_add_u32 s33, s40, s44
  s_add_u32 s34, s33, 1280
  s_add_u32 s35, s33, 2560
  s_add_u32 s36, s33, 3840
  v_mfma_f32_16x16x32_bf16 v[32:35], v[240:243], v[148:151], v[32:35]
  buffer_load_dwordx4 v[208:211], v1, s[12:15], s32 offen sc1
  v_mfma_f32_16x16x32_bf16 v[48:51], v[240:243], v[152:155], v[48:51]
  buffer_load_dwordx4 v[212:215], v1, s[12:15], s32 offen offset:1024 sc1
  v_mfma_f32_16x16x32_bf16 v[64:67], v[240:243], v[156:159], v[64:67]
  v_mfma_f32_16x16x32_bf16 v[80:83], v[240:243], v[160:163], v[80:83]
  buffer_load_dwordx4 v[216:219], v1, s[12:15], s32 offen offset:2048 sc1
  v_mfma_f32_16x16x32_bf16 v[96:99], v[240:243], v[164:167], v[96:99]
  v_mfma_f32_16x16x32_bf16 v[112:115], v[240:243], v[168:171], v[112:115]
  buffer_load_dwordx4 v[220:223], v1, s[12:15], s32 offen offset:3072 sc1
  v_mfma_f32_16x16x32_bf16 v[128:131], v[240:243], v[172:175], v[128:131]
  s_waitcnt lgkmcnt(4)
  v_mfma_f32_16x16x32_bf16 v[20:23], v[244:247], v[144:147], v[20:23]
  buffer_load_dwordx4 v[224:227], v2, s[12:15], s32 offen sc1
  v_mfma_f32_16x16x32_bf16 v[36:39], v[244:247], v[148:151], v[36:39]
  v_mfma_f32_16x16x32_bf16 v[52:55], v[244:247], v[152:155], v[52:55]
  buffer_load_dwordx4 v[228:231], v2, s[12:15], s32 offen offset:1024 sc1
  v_mfma_f32_16x16x32_bf16 v[68:71], v[244:247], v[156:159], v[68:71]
  v_mfma_f32_16x16x32_bf16 v[84:87], v[244:247], v[160:163], v[84:87]
  buffer_load_dwordx4 v[232:235], v2, s[12:15], s32 offen offset:2048 sc1
  v_mfma_f32_16x16x32_bf16 v[100:103], v[244:247], v[164:167], v[100:103]
  buffer_load_dwordx4 v[236:239], v2, s[12:15], s32 offen offset:3072 sc1
  v_mfma_f32_16x16x32_bf16 v[116:119], v[244:247], v[168:171], v[116:119]
  v_mfma_f32_16x16x32_bf16 v[132:135], v[244:247], v[172:175], v[132:135]
  s_add_u32 m0, s37, 8448
  s_waitcnt lgkmcnt(2)
  v_mfma_f32_16x16x32_bf16 v[24:27], v[248:251], v[144:147], v[24:27]
  buffer_load_dwordx4 v3, s[16:19], s33 offen lds
  v_mfma_f32_16x16x32_bf16 v[40:43], v[248:251], v[148:151], v[40:43]
  s_add_u32 m0, s37, 9504
  v_mfma_f32_16x16x32_bf16 v[56:59], v[248:251], v[152:155], v[56:59]
  buffer_load_dwordx4 v3, s[16:19], s34 offen lds
  v_mfma_f32_16x16x32_bf16 v[72:75], v[248:251], v[156:159], v[72:75]
  s_add_u32 m0, s37, 10560
  v_mfma_f32_16x16x32_bf16 v[88:91], v[248:251], v[160:163], v[88:91]
  buffer_load_dwordx4 v3, s[16:19], s35 offen lds
  v_mfma_f32_16x16x32_bf16 v[104:107], v[248:251], v[164:167], v[104:107]
  s_add_u32 m0, s37, 11616
  v_mfma_f32_16x16x32_bf16 v[120:123], v[248:251], v[168:171], v[120:123]
  buffer_load_dwordx4 v3, s[16:19], s36 offen lds
  v_mfma_f32_16x16x32_bf16 v[136:139], v[248:251], v[172:175], v[136:139]
  s_waitcnt lgkmcnt(0)
  v_mfma_f32_16x16x32_bf16 v[28:31], v[252:255], v[144:147], v[28:31]
  s_waitcnt vmcnt(12)
  ds_read_b64_tr_b16 v[240:241], v4 offset:4224
  ds_read_b64_tr_b16 v[242:243], v4 offset:4736
  v_mfma_f32_16x16x32_bf16 v[44:47], v[252:255], v[148:151], v[44:47]
  ds_read_b64_tr_b16 v[244:245], v4 offset:4256
  ds_read_b64_tr_b16 v[246:247], v4 offset:4768
  v_mfma_f32_16x16x32_bf16 v[60:63], v[252:255], v[152:155], v[60:63]
  ds_read_b64_tr_b16 v[248:249], v4 offset:4288
  ds_read_b64_tr_b16 v[250:251], v4 offset:4800
  v_mfma_f32_16x16x32_bf16 v[76:79], v[252:255], v[156:159], v[76:79]
  v_mfma_f32_16x16x32_bf16 v[92:95], v[252:255], v[160:163], v[92:95]
  v_mfma_f32_16x16x32_bf16 v[108:111], v[252:255], v[164:167], v[108:111]
  v_mfma_f32_16x16x32_bf16 v[124:127], v[252:255], v[168:171], v[124:127]
  v_mfma_f32_16x16x32_bf16 v[140:143], v[252:255], v[172:175], v[140:143]
  ds_read_b64_tr_b16 v[252:253], v4 offset:4320
  ds_read_b64_tr_b16 v[254:255], v4 offset:4832
  s_waitcnt lgkmcnt(6)
  v_mfma_f32_16x16x32_bf16 v[16:19], v[240:243], v[176:179], v[16:19]
  s_cmp_lg_u32 s38, 0
  s_cbranch_scc1 concat_heads__mha_block_cached__gqa_block_cached__near_ridge_kernel_o_s4_have
  s_mov_b32 s43, 32
  s_cmp_eq_u32 s39, -1
  s_cbranch_scc1 concat_heads__mha_block_cached__gqa_block_cached__near_ridge_kernel_o_s4_addr
  s_mov_b32 s48, 200000
concat_heads__mha_block_cached__gqa_block_cached__near_ridge_kernel_o_s4_poll:
  buffer_load_dword v6, v5, s[24:27], 0 offen sc1
  s_waitcnt vmcnt(0)
  v_cmp_eq_u32 vcc, s73, v6
  s_sub_u32 s48, s48, 1
  s_cselect_b32 s44, -1, 0
  s_nop 2
  s_and_b32 s43, vcc_lo, vcc_hi
  s_or_b32 s44, s44, s43
  s_andn2_b32 s38, s44, s39
  s_cbranch_scc1 concat_heads__mha_block_cached__gqa_block_cached__near_ridge_kernel_o_s4_have
  s_sleep 64
  s_branch concat_heads__mha_block_cached__gqa_block_cached__near_ridge_kernel_o_s4_poll
concat_heads__mha_block_cached__gqa_block_cached__near_ridge_kernel_o_s4_have:
  s_mov_b32 s46, s38
  s_mov_b32 s47, s38
  s_lshr_b64 s[46:47], s[46:47], s9
  s_ff1_i32_b32 s43, s46
  s_add_u32 s43, s43, s9
  s_and_b32 s43, s43, 31
  s_lshl_b32 s44, 1, s43
  s_or_b32 s39, s39, s44
  s_andn2_b32 s38, s38, s44
concat_heads__mha_block_cached__gqa_block_cached__near_ridge_kernel_o_s4_addr:
  s_lshl_b32 s44, s43, 15
  s_add_u32 s32, s41, s44
  s_mul_i32 s44, s43, 163840
  s_add_u32 s33, s40, s44
  s_add_u32 s34, s33, 1280
  s_add_u32 s35, s33, 2560
  s_add_u32 s36, s33, 3840
  v_mfma_f32_16x16x32_bf16 v[32:35], v[240:243], v[180:183], v[32:35]
  buffer_load_dwordx4 v[144:147], v1, s[12:15], s32 offen sc1
  v_mfma_f32_16x16x32_bf16 v[48:51], v[240:243], v[184:187], v[48:51]
  buffer_load_dwordx4 v[148:151], v1, s[12:15], s32 offen offset:1024 sc1
  v_mfma_f32_16x16x32_bf16 v[64:67], v[240:243], v[188:191], v[64:67]
  v_mfma_f32_16x16x32_bf16 v[80:83], v[240:243], v[192:195], v[80:83]
  buffer_load_dwordx4 v[152:155], v1, s[12:15], s32 offen offset:2048 sc1
  v_mfma_f32_16x16x32_bf16 v[96:99], v[240:243], v[196:199], v[96:99]
  v_mfma_f32_16x16x32_bf16 v[112:115], v[240:243], v[200:203], v[112:115]
  buffer_load_dwordx4 v[156:159], v1, s[12:15], s32 offen offset:3072 sc1
  v_mfma_f32_16x16x32_bf16 v[128:131], v[240:243], v[204:207], v[128:131]
  s_waitcnt lgkmcnt(4)
  v_mfma_f32_16x16x32_bf16 v[20:23], v[244:247], v[176:179], v[20:23]
  buffer_load_dwordx4 v[160:163], v2, s[12:15], s32 offen sc1
  v_mfma_f32_16x16x32_bf16 v[36:39], v[244:247], v[180:183], v[36:39]
  v_mfma_f32_16x16x32_bf16 v[52:55], v[244:247], v[184:187], v[52:55]
  buffer_load_dwordx4 v[164:167], v2, s[12:15], s32 offen offset:1024 sc1
  v_mfma_f32_16x16x32_bf16 v[68:71], v[244:247], v[188:191], v[68:71]
  v_mfma_f32_16x16x32_bf16 v[84:87], v[244:247], v[192:195], v[84:87]
  buffer_load_dwordx4 v[168:171], v2, s[12:15], s32 offen offset:2048 sc1
  v_mfma_f32_16x16x32_bf16 v[100:103], v[244:247], v[196:199], v[100:103]
  buffer_load_dwordx4 v[172:175], v2, s[12:15], s32 offen offset:3072 sc1
  v_mfma_f32_16x16x32_bf16 v[116:119], v[244:247], v[200:203], v[116:119]
  v_mfma_f32_16x16x32_bf16 v[132:135], v[244:247], v[204:207], v[132:135]
  s_mov_b32 m0, s37
  s_waitcnt lgkmcnt(2)
  v_mfma_f32_16x16x32_bf16 v[24:27], v[248:251], v[176:179], v[24:27]
  buffer_load_dwordx4 v3, s[16:19], s33 offen lds
  v_mfma_f32_16x16x32_bf16 v[40:43], v[248:251], v[180:183], v[40:43]
  s_add_u32 m0, s37, 1056
  v_mfma_f32_16x16x32_bf16 v[56:59], v[248:251], v[184:187], v[56:59]
  buffer_load_dwordx4 v3, s[16:19], s34 offen lds
  v_mfma_f32_16x16x32_bf16 v[72:75], v[248:251], v[188:191], v[72:75]
  s_add_u32 m0, s37, 2112
  v_mfma_f32_16x16x32_bf16 v[88:91], v[248:251], v[192:195], v[88:91]
  buffer_load_dwordx4 v3, s[16:19], s35 offen lds
  v_mfma_f32_16x16x32_bf16 v[104:107], v[248:251], v[196:199], v[104:107]
  s_add_u32 m0, s37, 3168
  v_mfma_f32_16x16x32_bf16 v[120:123], v[248:251], v[200:203], v[120:123]
  buffer_load_dwordx4 v3, s[16:19], s36 offen lds
  v_mfma_f32_16x16x32_bf16 v[136:139], v[248:251], v[204:207], v[136:139]
  s_waitcnt lgkmcnt(0)
  v_mfma_f32_16x16x32_bf16 v[28:31], v[252:255], v[176:179], v[28:31]
  s_waitcnt vmcnt(12)
  ds_read_b64_tr_b16 v[240:241], v4 offset:8448
  ds_read_b64_tr_b16 v[242:243], v4 offset:8960
  v_mfma_f32_16x16x32_bf16 v[44:47], v[252:255], v[180:183], v[44:47]
  ds_read_b64_tr_b16 v[244:245], v4 offset:8480
  ds_read_b64_tr_b16 v[246:247], v4 offset:8992
  v_mfma_f32_16x16x32_bf16 v[60:63], v[252:255], v[184:187], v[60:63]
  ds_read_b64_tr_b16 v[248:249], v4 offset:8512
  ds_read_b64_tr_b16 v[250:251], v4 offset:9024
  v_mfma_f32_16x16x32_bf16 v[76:79], v[252:255], v[188:191], v[76:79]
  v_mfma_f32_16x16x32_bf16 v[92:95], v[252:255], v[192:195], v[92:95]
  v_mfma_f32_16x16x32_bf16 v[108:111], v[252:255], v[196:199], v[108:111]
  v_mfma_f32_16x16x32_bf16 v[124:127], v[252:255], v[200:203], v[124:127]
  v_mfma_f32_16x16x32_bf16 v[140:143], v[252:255], v[204:207], v[140:143]
  ds_read_b64_tr_b16 v[252:253], v4 offset:8544
  ds_read_b64_tr_b16 v[254:255], v4 offset:9056
  s_waitcnt lgkmcnt(6)
  v_mfma_f32_16x16x32_bf16 v[16:19], v[240:243], v[208:211], v[16:19]
  s_cmp_lg_u32 s38, 0
  s_cbranch_scc1 concat_heads__mha_block_cached__gqa_block_cached__near_ridge_kernel_o_s5_have
  s_mov_b32 s43, 32
  s_cmp_eq_u32 s39, -1
  s_cbranch_scc1 concat_heads__mha_block_cached__gqa_block_cached__near_ridge_kernel_o_s5_addr
  s_mov_b32 s48, 200000
concat_heads__mha_block_cached__gqa_block_cached__near_ridge_kernel_o_s5_poll:
  buffer_load_dword v6, v5, s[24:27], 0 offen sc1
  s_waitcnt vmcnt(0)
  v_cmp_eq_u32 vcc, s73, v6
  s_sub_u32 s48, s48, 1
  s_cselect_b32 s44, -1, 0
  s_nop 2
  s_and_b32 s43, vcc_lo, vcc_hi
  s_or_b32 s44, s44, s43
  s_andn2_b32 s38, s44, s39
  s_cbranch_scc1 concat_heads__mha_block_cached__gqa_block_cached__near_ridge_kernel_o_s5_have
  s_sleep 64
  s_branch concat_heads__mha_block_cached__gqa_block_cached__near_ridge_kernel_o_s5_poll
concat_heads__mha_block_cached__gqa_block_cached__near_ridge_kernel_o_s5_have:
  s_mov_b32 s46, s38
  s_mov_b32 s47, s38
  s_lshr_b64 s[46:47], s[46:47], s9
  s_ff1_i32_b32 s43, s46
  s_add_u32 s43, s43, s9
  s_and_b32 s43, s43, 31
  s_lshl_b32 s44, 1, s43
  s_or_b32 s39, s39, s44
  s_andn2_b32 s38, s38, s44
concat_heads__mha_block_cached__gqa_block_cached__near_ridge_kernel_o_s5_addr:
  s_lshl_b32 s44, s43, 15
  s_add_u32 s32, s41, s44
  s_mul_i32 s44, s43, 163840
  s_add_u32 s33, s40, s44
  s_add_u32 s34, s33, 1280
  s_add_u32 s35, s33, 2560
  s_add_u32 s36, s33, 3840
  v_mfma_f32_16x16x32_bf16 v[32:35], v[240:243], v[212:215], v[32:35]
  buffer_load_dwordx4 v[176:179], v1, s[12:15], s32 offen sc1
  v_mfma_f32_16x16x32_bf16 v[48:51], v[240:243], v[216:219], v[48:51]
  buffer_load_dwordx4 v[180:183], v1, s[12:15], s32 offen offset:1024 sc1
  v_mfma_f32_16x16x32_bf16 v[64:67], v[240:243], v[220:223], v[64:67]
  v_mfma_f32_16x16x32_bf16 v[80:83], v[240:243], v[224:227], v[80:83]
  buffer_load_dwordx4 v[184:187], v1, s[12:15], s32 offen offset:2048 sc1
  v_mfma_f32_16x16x32_bf16 v[96:99], v[240:243], v[228:231], v[96:99]
  v_mfma_f32_16x16x32_bf16 v[112:115], v[240:243], v[232:235], v[112:115]
  buffer_load_dwordx4 v[188:191], v1, s[12:15], s32 offen offset:3072 sc1
  v_mfma_f32_16x16x32_bf16 v[128:131], v[240:243], v[236:239], v[128:131]
  s_waitcnt lgkmcnt(4)
  v_mfma_f32_16x16x32_bf16 v[20:23], v[244:247], v[208:211], v[20:23]
  buffer_load_dwordx4 v[192:195], v2, s[12:15], s32 offen sc1
  v_mfma_f32_16x16x32_bf16 v[36:39], v[244:247], v[212:215], v[36:39]
  v_mfma_f32_16x16x32_bf16 v[52:55], v[244:247], v[216:219], v[52:55]
  buffer_load_dwordx4 v[196:199], v2, s[12:15], s32 offen offset:1024 sc1
  v_mfma_f32_16x16x32_bf16 v[68:71], v[244:247], v[220:223], v[68:71]
  v_mfma_f32_16x16x32_bf16 v[84:87], v[244:247], v[224:227], v[84:87]
  buffer_load_dwordx4 v[200:203], v2, s[12:15], s32 offen offset:2048 sc1
  v_mfma_f32_16x16x32_bf16 v[100:103], v[244:247], v[228:231], v[100:103]
  buffer_load_dwordx4 v[204:207], v2, s[12:15], s32 offen offset:3072 sc1
  v_mfma_f32_16x16x32_bf16 v[116:119], v[244:247], v[232:235], v[116:119]
  v_mfma_f32_16x16x32_bf16 v[132:135], v[244:247], v[236:239], v[132:135]
  s_add_u32 m0, s37, 4224
  s_waitcnt lgkmcnt(2)
  v_mfma_f32_16x16x32_bf16 v[24:27], v[248:251], v[208:211], v[24:27]
  buffer_load_dwordx4 v3, s[16:19], s33 offen lds
  v_mfma_f32_16x16x32_bf16 v[40:43], v[248:251], v[212:215], v[40:43]
  s_add_u32 m0, s37, 5280
  v_mfma_f32_16x16x32_bf16 v[56:59], v[248:251], v[216:219], v[56:59]
  buffer_load_dwordx4 v3, s[16:19], s34 offen lds
  v_mfma_f32_16x16x32_bf16 v[72:75], v[248:251], v[220:223], v[72:75]
  s_add_u32 m0, s37, 6336
  v_mfma_f32_16x16x32_bf16 v[88:91], v[248:251], v[224:227], v[88:91]
  buffer_load_dwordx4 v3, s[16:19], s35 offen lds
  v_mfma_f32_16x16x32_bf16 v[104:107], v[248:251], v[228:231], v[104:107]
  s_add_u32 m0, s37, 7392
  v_mfma_f32_16x16x32_bf16 v[120:123], v[248:251], v[232:235], v[120:123]
  buffer_load_dwordx4 v3, s[16:19], s36 offen lds
  v_mfma_f32_16x16x32_bf16 v[136:139], v[248:251], v[236:239], v[136:139]
  s_waitcnt lgkmcnt(0)
  v_mfma_f32_16x16x32_bf16 v[28:31], v[252:255], v[208:211], v[28:31]
  s_waitcnt vmcnt(12)
  ds_read_b64_tr_b16 v[240:241], v4 offset:0
  ds_read_b64_tr_b16 v[242:243], v4 offset:512
  v_mfma_f32_16x16x32_bf16 v[44:47], v[252:255], v[212:215], v[44:47]
  ds_read_b64_tr_b16 v[244:245], v4 offset:32
  ds_read_b64_tr_b16 v[246:247], v4 offset:544
  v_mfma_f32_16x16x32_bf16 v[60:63], v[252:255], v[216:219], v[60:63]
  ds_read_b64_tr_b16 v[248:249], v4 offset:64
  ds_read_b64_tr_b16 v[250:251], v4 offset:576
  v_mfma_f32_16x16x32_bf16 v[76:79], v[252:255], v[220:223], v[76:79]
  v_mfma_f32_16x16x32_bf16 v[92:95], v[252:255], v[224:227], v[92:95]
  v_mfma_f32_16x16x32_bf16 v[108:111], v[252:255], v[228:231], v[108:111]
  v_mfma_f32_16x16x32_bf16 v[124:127], v[252:255], v[232:235], v[124:127]
  v_mfma_f32_16x16x32_bf16 v[140:143], v[252:255], v[236:239], v[140:143]
  ds_read_b64_tr_b16 v[252:253], v4 offset:96
  ds_read_b64_tr_b16 v[254:255], v4 offset:608
  s_sub_u32 s42, s42, 1
  s_cmp_lg_u32 s42, 0
  s_cbranch_scc1 concat_heads__mha_block_cached__gqa_block_cached__near_ridge_kernel_o_loop
  s_waitcnt lgkmcnt(6)
  v_mfma_f32_16x16x32_bf16 v[16:19], v[240:243], v[144:147], v[16:19]
  v_mfma_f32_16x16x32_bf16 v[32:35], v[240:243], v[148:151], v[32:35]
  v_mfma_f32_16x16x32_bf16 v[48:51], v[240:243], v[152:155], v[48:51]
  v_mfma_f32_16x16x32_bf16 v[64:67], v[240:243], v[156:159], v[64:67]
  v_mfma_f32_16x16x32_bf16 v[80:83], v[240:243], v[160:163], v[80:83]
  v_mfma_f32_16x16x32_bf16 v[96:99], v[240:243], v[164:167], v[96:99]
  v_mfma_f32_16x16x32_bf16 v[112:115], v[240:243], v[168:171], v[112:115]
  v_mfma_f32_16x16x32_bf16 v[128:131], v[240:243], v[172:175], v[128:131]
  s_waitcnt lgkmcnt(4)
  v_mfma_f32_16x16x32_bf16 v[20:23], v[244:247], v[144:147], v[20:23]
  v_mfma_f32_16x16x32_bf16 v[36:39], v[244:247], v[148:151], v[36:39]
  v_mfma_f32_16x16x32_bf16 v[52:55], v[244:247], v[152:155], v[52:55]
  v_mfma_f32_16x16x32_bf16 v[68:71], v[244:247], v[156:159], v[68:71]
  v_mfma_f32_16x16x32_bf16 v[84:87], v[244:247], v[160:163], v[84:87]
  v_mfma_f32_16x16x32_bf16 v[100:103], v[244:247], v[164:167], v[100:103]
  v_mfma_f32_16x16x32_bf16 v[116:119], v[244:247], v[168:171], v[116:119]
  v_mfma_f32_16x16x32_bf16 v[132:135], v[244:247], v[172:175], v[132:135]
  s_waitcnt lgkmcnt(2)
  v_mfma_f32_16x16x32_bf16 v[24:27], v[248:251], v[144:147], v[24:27]
  v_mfma_f32_16x16x32_bf16 v[40:43], v[248:251], v[148:151], v[40:43]
  v_mfma_f32_16x16x32_bf16 v[56:59], v[248:251], v[152:155], v[56:59]
  v_mfma_f32_16x16x32_bf16 v[72:75], v[248:251], v[156:159], v[72:75]
  v_mfma_f32_16x16x32_bf16 v[88:91], v[248:251], v[160:163], v[88:91]
  v_mfma_f32_16x16x32_bf16 v[104:107], v[248:251], v[164:167], v[104:107]
  v_mfma_f32_16x16x32_bf16 v[120:123], v[248:251], v[168:171], v[120:123]
  v_mfma_f32_16x16x32_bf16 v[136:139], v[248:251], v[172:175], v[136:139]
  s_waitcnt lgkmcnt(0)
  v_mfma_f32_16x16x32_bf16 v[28:31], v[252:255], v[144:147], v[28:31]
  s_waitcnt vmcnt(0)
  ds_read_b64_tr_b16 v[240:241], v4 offset:4224
  ds_read_b64_tr_b16 v[242:243], v4 offset:4736
  v_mfma_f32_16x16x32_bf16 v[44:47], v[252:255], v[148:151], v[44:47]
  ds_read_b64_tr_b16 v[244:245], v4 offset:4256
  ds_read_b64_tr_b16 v[246:247], v4 offset:4768
  v_mfma_f32_16x16x32_bf16 v[60:63], v[252:255], v[152:155], v[60:63]
  ds_read_b64_tr_b16 v[248:249], v4 offset:4288
  ds_read_b64_tr_b16 v[250:251], v4 offset:4800
  v_mfma_f32_16x16x32_bf16 v[76:79], v[252:255], v[156:159], v[76:79]
  v_mfma_f32_16x16x32_bf16 v[92:95], v[252:255], v[160:163], v[92:95]
  v_mfma_f32_16x16x32_bf16 v[108:111], v[252:255], v[164:167], v[108:111]
  v_mfma_f32_16x16x32_bf16 v[124:127], v[252:255], v[168:171], v[124:127]
  v_mfma_f32_16x16x32_bf16 v[140:143], v[252:255], v[172:175], v[140:143]
  ds_read_b64_tr_b16 v[252:253], v4 offset:4320
  ds_read_b64_tr_b16 v[254:255], v4 offset:4832
  s_waitcnt lgkmcnt(6)
  v_mfma_f32_16x16x32_bf16 v[16:19], v[240:243], v[176:179], v[16:19]
  v_mfma_f32_16x16x32_bf16 v[32:35], v[240:243], v[180:183], v[32:35]
  v_mfma_f32_16x16x32_bf16 v[48:51], v[240:243], v[184:187], v[48:51]
  v_mfma_f32_16x16x32_bf16 v[64:67], v[240:243], v[188:191], v[64:67]
  v_mfma_f32_16x16x32_bf16 v[80:83], v[240:243], v[192:195], v[80:83]
  v_mfma_f32_16x16x32_bf16 v[96:99], v[240:243], v[196:199], v[96:99]
  v_mfma_f32_16x16x32_bf16 v[112:115], v[240:243], v[200:203], v[112:115]
  v_mfma_f32_16x16x32_bf16 v[128:131], v[240:243], v[204:207], v[128:131]
  s_waitcnt lgkmcnt(4)
  v_mfma_f32_16x16x32_bf16 v[20:23], v[244:247], v[176:179], v[20:23]
  v_mfma_f32_16x16x32_bf16 v[36:39], v[244:247], v[180:183], v[36:39]
  v_mfma_f32_16x16x32_bf16 v[52:55], v[244:247], v[184:187], v[52:55]
  v_mfma_f32_16x16x32_bf16 v[68:71], v[244:247], v[188:191], v[68:71]
  v_mfma_f32_16x16x32_bf16 v[84:87], v[244:247], v[192:195], v[84:87]
  v_mfma_f32_16x16x32_bf16 v[100:103], v[244:247], v[196:199], v[100:103]
  v_mfma_f32_16x16x32_bf16 v[116:119], v[244:247], v[200:203], v[116:119]
  v_mfma_f32_16x16x32_bf16 v[132:135], v[244:247], v[204:207], v[132:135]
  s_waitcnt lgkmcnt(2)
  v_mfma_f32_16x16x32_bf16 v[24:27], v[248:251], v[176:179], v[24:27]
  v_mfma_f32_16x16x32_bf16 v[40:43], v[248:251], v[180:183], v[40:43]
  v_mfma_f32_16x16x32_bf16 v[56:59], v[248:251], v[184:187], v[56:59]
  v_mfma_f32_16x16x32_bf16 v[72:75], v[248:251], v[188:191], v[72:75]
  v_mfma_f32_16x16x32_bf16 v[88:91], v[248:251], v[192:195], v[88:91]
  v_mfma_f32_16x16x32_bf16 v[104:107], v[248:251], v[196:199], v[104:107]
  v_mfma_f32_16x16x32_bf16 v[120:123], v[248:251], v[200:203], v[120:123]
  v_mfma_f32_16x16x32_bf16 v[136:139], v[248:251], v[204:207], v[136:139]
  s_waitcnt lgkmcnt(0)
  v_mfma_f32_16x16x32_bf16 v[28:31], v[252:255], v[176:179], v[28:31]
  v_mfma_f32_16x16x32_bf16 v[44:47], v[252:255], v[180:183], v[44:47]
  v_mfma_f32_16x16x32_bf16 v[60:63], v[252:255], v[184:187], v[60:63]
  v_mfma_f32_16x16x32_bf16 v[76:79], v[252:255], v[188:191], v[76:79]
  v_mfma_f32_16x16x32_bf16 v[92:95], v[252:255], v[192:195], v[92:95]
  v_mfma_f32_16x16x32_bf16 v[108:111], v[252:255], v[196:199], v[108:111]
  v_mfma_f32_16x16x32_bf16 v[124:127], v[252:255], v[200:203], v[124:127]
  v_mfma_f32_16x16x32_bf16 v[140:143], v[252:255], v[204:207], v[140:143]
  v_lshlrev_b32 v11, 4, v0
  s_lshl_b32 s43, s4, 14
  v_add_u32 v12, s43, v11
  s_lshl_b32 s43, s4, 12
  v_add_u32 v13, s43, v11
  v_and_b32 v14, 1, v7
  v_lshlrev_b32 v14, 1, v14
  v_lshrrev_b32 v15, 1, v7
  v_or_b32 v14, v14, v15
  v_lshlrev_b32 v14, 4, v14
  v_mul_u32_u24 v15, 2560, v8
  v_add_u32 v14, v14, v15
  s_mul_i32 s43, s4, 40960
  s_add_u32 s44, s43, 163840
  s_waitcnt vmcnt(0) lgkmcnt(0)
  s_barrier
  ds_write_b128 v12, v[16:19] offset:0
  ds_write_b128 v12, v[20:23] offset:1024
  ds_write_b128 v12, v[24:27] offset:2048
  ds_write_b128 v12, v[28:31] offset:3072
  ds_write_b128 v12, v[32:35] offset:4096
  ds_write_b128 v12, v[36:39] offset:5120
  ds_write_b128 v12, v[40:43] offset:6144
  ds_write_b128 v12, v[44:47] offset:7168
  ds_write_b128 v12, v[48:51] offset:8192
  ds_write_b128 v12, v[52:55] offset:9216
  ds_write_b128 v12, v[56:59] offset:10240
  ds_write_b128 v12, v[60:63] offset:11264
  ds_write_b128 v12, v[64:67] offset:12288
  ds_write_b128 v12, v[68:71] offset:13312
  ds_write_b128 v12, v[72:75] offset:14336
  ds_write_b128 v12, v[76:79] offset:15360
  s_waitcnt lgkmcnt(0)
  s_barrier
  ds_read_b128 v[144:147], v13 offset:0
  ds_read_b128 v[160:163], v13 offset:16384
  ds_read_b128 v[176:179], v13 offset:32768
  ds_read_b128 v[192:195], v13 offset:49152
  ds_read_b128 v[148:151], v13 offset:1024
  ds_read_b128 v[164:167], v13 offset:17408
  ds_read_b128 v[180:183], v13 offset:33792
  ds_read_b128 v[196:199], v13 offset:50176
  ds_read_b128 v[152:155], v13 offset:2048
  ds_read_b128 v[168:171], v13 offset:18432
  ds_read_b128 v[184:187], v13 offset:34816
  ds_read_b128 v[200:203], v13 offset:51200
  ds_read_b128 v[156:159], v13 offset:3072
  ds_read_b128 v[172:175], v13 offset:19456
  ds_read_b128 v[188:191], v13 offset:35840
  ds_read_b128 v[204:207], v13 offset:52224
  s_waitcnt lgkmcnt(0)
  s_barrier
  ds_write_b128 v12, v[80:83] offset:0
  ds_write_b128 v12, v[84:87] offset:1024
  ds_write_b128 v12, v[88:91] offset:2048
  ds_write_b128 v12, v[92:95] offset:3072
  ds_write_b128 v12, v[96:99] offset:4096
  ds_write_b128 v12, v[100:103] offset:5120
  ds_write_b128 v12, v[104:107] offset:6144
  ds_write_b128 v12, v[108:111] offset:7168
  ds_write_b128 v12, v[112:115] offset:8192
  ds_write_b128 v12, v[116:119] offset:9216
  ds_write_b128 v12, v[120:123] offset:10240
  ds_write_b128 v12, v[124:127] offset:11264
  ds_write_b128 v12, v[128:131] offset:12288
  ds_write_b128 v12, v[132:135] offset:13312
  ds_write_b128 v12, v[136:139] offset:14336
  ds_write_b128 v12, v[140:143] offset:15360
  v_add_f32 v144, v144, v160
  v_add_f32 v176, v176, v192
  v_add_f32 v145, v145, v161
  v_add_f32 v177, v177, v193
  v_add_f32 v146, v146, v162
  v_add_f32 v178, v178, v194
  v_add_f32 v147, v147, v163
  v_add_f32 v179, v179, v195
  v_add_f32 v144, v144, v176
  v_add_f32 v145, v145, v177
  v_add_f32 v146, v146, v178
  v_add_f32 v147, v147, v179
  v_add_f32 v148, v148, v164
  v_add_f32 v180, v180, v196
  v_add_f32 v149, v149, v165
  v_add_f32 v181, v181, v197
  v_add_f32 v150, v150, v166
  v_add_f32 v182, v182, v198
  v_add_f32 v151, v151, v167
  v_add_f32 v183, v183, v199
  v_add_f32 v148, v148, v180
  v_add_f32 v149, v149, v181
  v_add_f32 v150, v150, v182
  v_add_f32 v151, v151, v183
  v_cvt_pk_bf16_f32 v240, v144, v145
  v_cvt_pk_bf16_f32 v241, v146, v147
  v_cvt_pk_bf16_f32 v242, v148, v149
  v_cvt_pk_bf16_f32 v243, v150, v151
  s_nop 0
  v_permlane16_swap_b32 v240, v242
  v_permlane16_swap_b32 v241, v243
  buffer_store_dwordx4 v[240:243], v14, s[20:23], s43 offen sc1
  v_add_f32 v152, v152, v168
  v_add_f32 v184, v184, v200
  v_add_f32 v153, v153, v169
  v_add_f32 v185, v185, v201
  v_add_f32 v154, v154, v170
  v_add_f32 v186, v186, v202
  v_add_f32 v155, v155, v171
  v_add_f32 v187, v187, v203
  v_add_f32 v152, v152, v184
  v_add_f32 v153, v153, v185
  v_add_f32 v154, v154, v186
  v_add_f32 v155, v155, v187
  v_add_f32 v156, v156, v172
  v_add_f32 v188, v188, v204
  v_add_f32 v157, v157, v173
  v_add_f32 v189, v189, v205
  v_add_f32 v158, v158, v174
  v_add_f32 v190, v190, v206
  v_add_f32 v159, v159, v175
  v_add_f32 v191, v191, v207
  v_add_f32 v156, v156, v188
  v_add_f32 v157, v157, v189
  v_add_f32 v158, v158, v190
  v_add_f32 v159, v159, v191
  v_cvt_pk_bf16_f32 v244, v152, v153
  v_cvt_pk_bf16_f32 v245, v154, v155
  v_cvt_pk_bf16_f32 v246, v156, v157
  v_cvt_pk_bf16_f32 v247, v158, v159
  s_nop 0
  v_permlane16_swap_b32 v244, v246
  v_permlane16_swap_b32 v245, v247
  buffer_store_dwordx4 v[244:247], v14, s[20:23], s43 offen offset:64 sc1
  s_waitcnt lgkmcnt(0)
  s_barrier
  ds_read_b128 v[16:19], v13 offset:0
  ds_read_b128 v[32:35], v13 offset:16384
  ds_read_b128 v[48:51], v13 offset:32768
  ds_read_b128 v[64:67], v13 offset:49152
  ds_read_b128 v[20:23], v13 offset:1024
  ds_read_b128 v[36:39], v13 offset:17408
  ds_read_b128 v[52:55], v13 offset:33792
  ds_read_b128 v[68:71], v13 offset:50176
  ds_read_b128 v[24:27], v13 offset:2048
  ds_read_b128 v[40:43], v13 offset:18432
  ds_read_b128 v[56:59], v13 offset:34816
  ds_read_b128 v[72:75], v13 offset:51200
  ds_read_b128 v[28:31], v13 offset:3072
  ds_read_b128 v[44:47], v13 offset:19456
  ds_read_b128 v[60:63], v13 offset:35840
  ds_read_b128 v[76:79], v13 offset:52224
  s_waitcnt lgkmcnt(14)
  v_add_f32 v16, v16, v32
  s_waitcnt lgkmcnt(12)
  v_add_f32 v48, v48, v64
  v_add_f32 v17, v17, v33
  v_add_f32 v49, v49, v65
  v_add_f32 v18, v18, v34
  v_add_f32 v50, v50, v66
  v_add_f32 v19, v19, v35
  v_add_f32 v51, v51, v67
  v_add_f32 v16, v16, v48
  v_add_f32 v17, v17, v49
  v_add_f32 v18, v18, v50
  v_add_f32 v19, v19, v51
  s_waitcnt lgkmcnt(10)
  v_add_f32 v20, v20, v36
  s_waitcnt lgkmcnt(8)
  v_add_f32 v52, v52, v68
  v_add_f32 v21, v21, v37
  v_add_f32 v53, v53, v69
  v_add_f32 v22, v22, v38
  v_add_f32 v54, v54, v70
  v_add_f32 v23, v23, v39
  v_add_f32 v55, v55, v71
  v_add_f32 v20, v20, v52
  v_add_f32 v21, v21, v53
  v_add_f32 v22, v22, v54
  v_add_f32 v23, v23, v55
  v_cvt_pk_bf16_f32 v248, v16, v17
  v_cvt_pk_bf16_f32 v249, v18, v19
  v_cvt_pk_bf16_f32 v250, v20, v21
  v_cvt_pk_bf16_f32 v251, v22, v23
  s_nop 0
  v_permlane16_swap_b32 v248, v250
  v_permlane16_swap_b32 v249, v251
  buffer_store_dwordx4 v[248:251], v14, s[20:23], s44 offen sc1
  s_waitcnt lgkmcnt(6)
  v_add_f32 v24, v24, v40
  s_waitcnt lgkmcnt(4)
  v_add_f32 v56, v56, v72
  v_add_f32 v25, v25, v41
  v_add_f32 v57, v57, v73
  v_add_f32 v26, v26, v42
  v_add_f32 v58, v58, v74
  v_add_f32 v27, v27, v43
  v_add_f32 v59, v59, v75
  v_add_f32 v24, v24, v56
  v_add_f32 v25, v25, v57
  v_add_f32 v26, v26, v58
  v_add_f32 v27, v27, v59
  s_waitcnt lgkmcnt(2)
  v_add_f32 v28, v28, v44
  s_waitcnt lgkmcnt(0)
  v_add_f32 v60, v60, v76
  v_add_f32 v29, v29, v45
  v_add_f32 v61, v61, v77
  v_add_f32 v30, v30, v46
  v_add_f32 v62, v62, v78
  v_add_f32 v31, v31, v47
  v_add_f32 v63, v63, v79
  v_add_f32 v28, v28, v60
  v_add_f32 v29, v29, v61
  v_add_f32 v30, v30, v62
  v_add_f32 v31, v31, v63
  v_cvt_pk_bf16_f32 v252, v24, v25
  v_cvt_pk_bf16_f32 v253, v26, v27
  v_cvt_pk_bf16_f32 v254, v28, v29
  v_cvt_pk_bf16_f32 v255, v30, v31
  s_nop 0
  v_permlane16_swap_b32 v252, v254
  v_permlane16_swap_b32 v253, v255
  buffer_store_dwordx4 v[252:255], v14, s[20:23], s44 offen offset:64 sc1
concat_heads__mha_block_cached__gqa_block_cached__near_ridge_kernel_end:
  s_endpgm
.section .rodata,"a"
.p2align 6
.amdhsa_kernel concat_heads__mha_block_cached__gqa_block_cached__near_ridge_kernel
  .amdhsa_next_free_vgpr 256
  .amdhsa_next_free_sgpr 100
  .amdhsa_accum_offset 256
  .amdhsa_group_segment_fixed_size 0
  .amdhsa_kernarg_size 104
  .amdhsa_user_sgpr_count 2
  .amdhsa_user_sgpr_kernarg_segment_ptr 1
  .amdhsa_system_sgpr_workgroup_id_x 1
.end_amdhsa_kernel
```
